```python
import torch

def _softmax(x, axis=-1):
    return torch.softmax(x, dim=axis)
def _gelu(x):
    return torch.nn.functional.gelu(x, approximate="tanh")
def _silu(x):
    return torch.nn.functional.silu(x)
def _sigmoid(x):
    return torch.sigmoid(x)
def _layernorm(x, axis=-1, eps=1e-5):
    m = x.mean(dim=axis, keepdim=True)
    v = x.var(dim=axis, keepdim=True, unbiased=False)
    return (x - m) / torch.sqrt(v + eps)
def _scatter_add(tgt, idx, src, axis=0):
    return tgt.clone().index_add_(axis, idx, src)
def _segment_sum(src, seg, n):
    out = torch.zeros((n,) + src.shape[1:], dtype=src.dtype)
    return out.index_add_(0, seg, src)
def _pad(x, pw):
    flat = tuple(v for pair in reversed(pw) for v in pair)
    return torch.nn.functional.pad(x, flat)

kernel_name = 'standalone__mha_softmax__near_ridge'

def setup_inputs():

    _w = (lambda a: (lambda t: t.to(torch.bfloat16) if t.is_floating_point() else t)(torch.as_tensor(a)))
    B, H, Sq, Sk, D = 8, 32, 256, 2048, 128
    return {
        "q": _w((lambda *s: torch.randn(*s, dtype=torch.bfloat16) * 0.8)(B, H, Sq, D)),
        "k": _w((lambda *s: torch.randn(*s, dtype=torch.bfloat16) * 0.8)(B, H, Sk, D)),
        "v": _w((lambda *s: torch.randn(*s, dtype=torch.bfloat16) * 0.05)(B, H, Sk, D)),
    }

def reference(q, k, v):
    scale = q.shape[-1] ** -0.5
    scores = torch.einsum("bhqd,bhkd->bhqk", q, k) * scale
    p = _softmax(scores, axis=-1)
    return torch.einsum("bhqk,bhkd->bhqd", p, v)
```

```asm
; @launch grid=(256,1,1) block=(256,1,1) lds=135232
.amdgcn_target "amdgcn-amd-amdhsa--gfx950"
.text
.p2align 12
.globl standalone__mha_softmax__near_ridge_kernel
.p2align 8
.type standalone__mha_softmax__near_ridge_kernel,@function
standalone__mha_softmax__near_ridge_kernel:
s_cmp_ge_u32 s2, 256
s_cbranch_scc1 L_end
s_load_dwordx4 s[24:27], s[0:1], 0
s_load_dwordx4 s[28:31], s[0:1], 16
s_getpc_b64 s[36:37]
L_pc:
v_lshlrev_b32 v1, 7, v0
v_min_u32 v1, L_end-L_pc, v1
global_load_dword v11, v1, s[36:37]
v_lshrrev_b32 v1, 6, v0
v_and_b32 v0, 63, v0
s_nop 0
v_readfirstlane_b32 s3, v1
v_lshrrev_b32 v20, 4, v0
v_and_b32 v21, 15, v0
s_mul_i32 s22, s3, 4224
s_and_b32 s36, s3, 1
s_lshl_b32 s36, s36, 10
s_lshr_b32 s37, s3, 1
s_lshl_b32 s37, s37, 11
s_add_u32 s36, s36, s37
v_and_b32 v22, 1, v20
v_lshlrev_b32 v22, 8, v22
v_lshl_add_u32 v22, v21, 4, v22
v_lshrrev_b32 v23, 1, v20
v_lshl_add_u32 v22, v23, 15, v22
v_add_u32 v22, s36, v22
s_mov_b32 s91, 0
s_mov_b32 s92, 483328
s_mov_b32 s93, 0
s_bfe_u32 s36, s2, 65540
s_lshl_b32 s36, s36, 12
s_xor_b32 s93, s93, s36
s_bfe_u32 s36, s2, 65541
s_lshl_b32 s36, s36, 13
s_xor_b32 s91, s91, s36
v_add_u32 v2, 0, v22
v_xor_b32 v2, s93, v2
v_add_u32 v2, 3168, v2
v_add_u32 v3, 512, v22
v_xor_b32 v3, s93, v3
v_add_u32 v3, 2112, v3
v_add_u32 v4, 4096, v22
v_xor_b32 v4, s93, v4
v_add_u32 v4, 1056, v4
v_add_u32 v5, 4608, v22
v_xor_b32 v5, s93, v5
v_add_u32 v5, 0, v5
s_lshl_b32 s36, s3, 14
v_lshlrev_b32 v23, 2, v20
v_xor_b32 v23, v23, v21
v_lshlrev_b32 v23, 4, v23
v_lshl_add_u32 v23, v20, 8, v23
v_add_u32 v8, s36, v23
v_bfe_u32 v23, v0, 3, 1
v_lshl_add_u32 v23, v20, 2, v23
v_and_b32 v24, 3, v0
v_lshlrev_b32 v24, 5, v24
v_lshl_add_u32 v23, v23, 8, v24
v_bfe_u32 v24, v0, 2, 1
v_lshl_add_u32 v23, v24, 4, v23
v_add_u32 v9, s36, v23
s_mov_b32 s80, 0
s_mov_b32 s81, 4096
s_mov_b32 s82, 8192
s_mov_b32 s83, 12288
s_lshl_b32 s88, s2, 19
s_sub_u32 s88, s88, 3168
s_subb_u32 s89, 0, 0
s_lshl_b32 s90, s2, 16
s_mov_b32 s10, 527456
s_mov_b32 s11, 0x20000
s_mov_b32 s14, 527456
s_mov_b32 s15, 0x20000
s_mov_b32 s6, 65536
s_mov_b32 s7, 0x20000
s_mov_b32 s18, 65536
s_mov_b32 s19, 0x20000
s_mov_b32 s32, 0
v_mov_b32 v16, 0xff800000
v_mov_b32 v17, 0xff800000
v_mov_b32 v18, 0xff800000
v_mov_b32 v19, 0xff800000
L_start:
s_mov_b32 s20, s91
s_mov_b32 s21, s91
s_mov_b32 s96, 458752
s_and_b32 s94, s91, s96
s_mov_b32 s95, s94
s_andn2_b32 s97, s91, s96
s_add_u32 m0, s22, 0
s_waitcnt lgkmcnt(0)
s_add_u32 s8, s26, s88
s_addc_u32 s9, s27, s89
buffer_load_dwordx4 v2, s[8:11], s20 offen offset:0 nt lds
s_add_u32 s4, s24, s90
s_addc_u32 s5, s25, 0
buffer_load_dwordx4 v3, s[8:11], s20 offen offset:1056 nt lds
buffer_load_dwordx4 v4, s[8:11], s20 offen offset:2112 nt lds
buffer_load_dwordx4 v5, s[8:11], s20 offen offset:3168 nt lds
s_xor_b32 s20, s20, 8192
s_add_u32 m0, s22, 67584
s_nop 0
buffer_load_dwordx4 v8, s[4:7], s80 offen offset:0 nt lds
s_add_u32 m0, s22, 65568
s_nop 0
buffer_load_dwordx4 v8, s[4:7], s80 offen offset:3072 nt lds
s_add_u32 m0, s22, 68672
s_nop 0
buffer_load_dwordx4 v8, s[4:7], s80 offen offset:1024 nt lds
s_add_u32 m0, s22, 68704
s_nop 0
buffer_load_dwordx4 v8, s[4:7], s80 offen offset:2048 nt lds
s_add_u32 s12, s28, s88
s_addc_u32 s13, s29, s89
s_add_u32 s16, s30, s90
s_addc_u32 s17, s31, 0
v_and_b32 v22, 3, v0
v_bfe_u32 v23, v0, 2, 1
v_lshl_add_u32 v22, v22, 1, v23
v_and_b32 v23, 8, v0
v_add_u32 v22, v22, v23
v_mul_u32_u24 v22, 1056, v22
v_lshrrev_b32 v23, 4, v0
v_lshl_add_u32 v6, v23, 4, v22
v_bfe_u32 v22, v0, 2, 2
v_bfe_u32 v23, v0, 4, 1
v_lshl_add_u32 v22, v22, 1, v23
v_lshrrev_b32 v23, 5, v0
v_lshl_add_u32 v22, v23, 3, v22
v_mul_u32_u24 v22, 1056, v22
v_and_b32 v23, 3, v0
v_lshl_add_u32 v22, v23, 3, v22
v_add_u32 v7, 67584, v22
v_bfe_u32 v22, v0, 2, 2
v_lshlrev_b32 v22, 1, v22
v_mov_b32 v23, 0x78
v_lshrrev_b32 v22, v22, v23
v_and_b32 v22, 3, v22
v_mul_u32_u24 v22, 1056, v22
v_and_b32 v23, 3, v0
v_lshl_add_u32 v22, v23, 8, v22
v_lshrrev_b32 v24, 4, v0
v_lshl_add_u32 v22, v24, 4, v22
v_add_u32 v22, s22, v22
v_add_u32 v22, 67584, v22
v_xor_b32 v24, 0, v23
v_lshl_add_u32 v40, v24, 6, v22
v_xor_b32 v24, 1, v23
v_lshl_add_u32 v41, v24, 6, v22
v_xor_b32 v24, 2, v23
v_lshl_add_u32 v42, v24, 6, v22
v_xor_b32 v24, 3, v23
v_lshl_add_u32 v43, v24, 6, v22
v_lshrrev_b32 v100, 4, v0
v_lshlrev_b32 v101, 9, v100
v_add_u32 v101, s22, v101
v_and_b32 v100, 1, v100
v_lshlrev_b32 v100, 2, v100
v_and_b32 v102, 15, v0
v_xor_b32 v102, v102, v100
v_lshl_add_u32 v32, v102, 3, v101
v_bfe_u32 v102, v0, 1, 1
v_lshl_add_u32 v101, v102, 7, v101
v_and_b32 v102, 1, v0
v_bfe_u32 v103, v0, 2, 2
v_lshl_add_u32 v102, v102, 3, v103
v_xor_b32 v102, v102, v100
v_lshl_add_u32 v44, v102, 3, v101
v_xor_b32 v102, 4, v102
v_lshl_add_u32 v37, v102, 3, v101
s_mov_b32 s34, 0x3e0293ee
s_mov_b32 s35, 0x3e0293ee
s_mov_b32 s23, 6
v_subrev_u32 v33, 67584, v7
s_mov_b32 s84, 0x07060302
v_and_b32 v22, 3, v0
v_cmp_gt_u32 vcc, 2, v22
v_mov_b32 v23, 0x3f803f80
v_and_b32 v22, 1, v0
v_cndmask_b32 v80, 0, v23, vcc
v_cmp_eq_u32 vcc, 0, v22
v_mov_b32 v23, 0x44444444
v_mov_b32 v24, 0xeeeeeeee
v_cndmask_b32 v45, v24, v23, vcc
v_mov_b32 v81, v80
v_mov_b32 v82, v80
v_mov_b32 v83, v80
v_accvgpr_write_b32 a0, 0
v_accvgpr_write_b32 a1, 0
v_accvgpr_write_b32 a2, 0
v_accvgpr_write_b32 a3, 0
v_accvgpr_write_b32 a4, 0
v_accvgpr_write_b32 a5, 0
v_accvgpr_write_b32 a6, 0
v_accvgpr_write_b32 a7, 0
v_accvgpr_write_b32 a8, 0
v_accvgpr_write_b32 a9, 0
v_accvgpr_write_b32 a10, 0
v_accvgpr_write_b32 a11, 0
v_accvgpr_write_b32 a12, 0
v_accvgpr_write_b32 a13, 0
v_accvgpr_write_b32 a14, 0
v_accvgpr_write_b32 a15, 0
v_accvgpr_write_b32 a16, 0
v_accvgpr_write_b32 a17, 0
v_accvgpr_write_b32 a18, 0
v_accvgpr_write_b32 a19, 0
v_accvgpr_write_b32 a20, 0
v_accvgpr_write_b32 a21, 0
v_accvgpr_write_b32 a22, 0
v_accvgpr_write_b32 a23, 0
v_accvgpr_write_b32 a24, 0
v_accvgpr_write_b32 a25, 0
v_accvgpr_write_b32 a26, 0
v_accvgpr_write_b32 a27, 0
v_accvgpr_write_b32 a28, 0
v_accvgpr_write_b32 a29, 0
v_accvgpr_write_b32 a30, 0
v_accvgpr_write_b32 a31, 0
v_accvgpr_write_b32 a32, 0
v_accvgpr_write_b32 a33, 0
v_accvgpr_write_b32 a34, 0
v_accvgpr_write_b32 a35, 0
v_accvgpr_write_b32 a36, 0
v_accvgpr_write_b32 a37, 0
v_accvgpr_write_b32 a38, 0
v_accvgpr_write_b32 a39, 0
v_accvgpr_write_b32 a40, 0
v_accvgpr_write_b32 a41, 0
v_accvgpr_write_b32 a42, 0
v_accvgpr_write_b32 a43, 0
v_accvgpr_write_b32 a44, 0
v_accvgpr_write_b32 a45, 0
v_accvgpr_write_b32 a46, 0
v_accvgpr_write_b32 a47, 0
v_accvgpr_write_b32 a48, 0
v_accvgpr_write_b32 a49, 0
v_accvgpr_write_b32 a50, 0
v_accvgpr_write_b32 a51, 0
v_accvgpr_write_b32 a52, 0
v_accvgpr_write_b32 a53, 0
v_accvgpr_write_b32 a54, 0
v_accvgpr_write_b32 a55, 0
v_accvgpr_write_b32 a56, 0
v_accvgpr_write_b32 a57, 0
v_accvgpr_write_b32 a58, 0
v_accvgpr_write_b32 a59, 0
v_accvgpr_write_b32 a60, 0
v_accvgpr_write_b32 a61, 0
v_accvgpr_write_b32 a62, 0
v_accvgpr_write_b32 a63, 0
v_accvgpr_write_b32 a64, 0
v_accvgpr_write_b32 a65, 0
v_accvgpr_write_b32 a66, 0
v_accvgpr_write_b32 a67, 0
v_accvgpr_write_b32 a68, 0
v_accvgpr_write_b32 a69, 0
v_accvgpr_write_b32 a70, 0
v_accvgpr_write_b32 a71, 0
v_accvgpr_write_b32 a72, 0
v_accvgpr_write_b32 a73, 0
v_accvgpr_write_b32 a74, 0
v_accvgpr_write_b32 a75, 0
v_accvgpr_write_b32 a76, 0
v_accvgpr_write_b32 a77, 0
v_accvgpr_write_b32 a78, 0
v_accvgpr_write_b32 a79, 0
v_accvgpr_write_b32 a80, 0
v_accvgpr_write_b32 a81, 0
v_accvgpr_write_b32 a82, 0
v_accvgpr_write_b32 a83, 0
v_accvgpr_write_b32 a84, 0
v_accvgpr_write_b32 a85, 0
v_accvgpr_write_b32 a86, 0
v_accvgpr_write_b32 a87, 0
v_accvgpr_write_b32 a88, 0
v_accvgpr_write_b32 a89, 0
v_accvgpr_write_b32 a90, 0
v_accvgpr_write_b32 a91, 0
v_accvgpr_write_b32 a92, 0
v_accvgpr_write_b32 a93, 0
v_accvgpr_write_b32 a94, 0
v_accvgpr_write_b32 a95, 0
v_accvgpr_write_b32 a96, 0
v_accvgpr_write_b32 a97, 0
v_accvgpr_write_b32 a98, 0
v_accvgpr_write_b32 a99, 0
v_accvgpr_write_b32 a100, 0
v_accvgpr_write_b32 a101, 0
v_accvgpr_write_b32 a102, 0
v_accvgpr_write_b32 a103, 0
v_accvgpr_write_b32 a104, 0
v_accvgpr_write_b32 a105, 0
v_accvgpr_write_b32 a106, 0
v_accvgpr_write_b32 a107, 0
v_accvgpr_write_b32 a108, 0
v_accvgpr_write_b32 a109, 0
v_accvgpr_write_b32 a110, 0
v_accvgpr_write_b32 a111, 0
v_accvgpr_write_b32 a112, 0
v_accvgpr_write_b32 a113, 0
v_accvgpr_write_b32 a114, 0
v_accvgpr_write_b32 a115, 0
v_accvgpr_write_b32 a116, 0
v_accvgpr_write_b32 a117, 0
v_accvgpr_write_b32 a118, 0
v_accvgpr_write_b32 a119, 0
v_accvgpr_write_b32 a120, 0
v_accvgpr_write_b32 a121, 0
v_accvgpr_write_b32 a122, 0
v_accvgpr_write_b32 a123, 0
v_accvgpr_write_b32 a124, 0
v_accvgpr_write_b32 a125, 0
v_accvgpr_write_b32 a126, 0
v_accvgpr_write_b32 a127, 0
v_mov_b32 v84, 0
v_mov_b32 v85, 0
v_mov_b32 v86, 0
v_mov_b32 v87, 0
v_mov_b32 v88, 0
v_mov_b32 v89, 0
v_mov_b32 v90, 0
v_mov_b32 v91, 0
v_mov_b32 v92, 0
v_mov_b32 v93, 0
v_mov_b32 v94, 0
v_mov_b32 v95, 0
v_mov_b32 v96, 0
v_mov_b32 v97, 0
v_mov_b32 v98, 0
v_mov_b32 v99, 0
v_mov_b32 v12, 0
v_mov_b32 v13, 0
v_mov_b32 v14, 0
v_mov_b32 v15, 0
s_waitcnt vmcnt(7)
s_add_u32 m0, s22, 84480
s_nop 0
buffer_load_dwordx4 v8, s[4:7], s81 offen offset:0 nt lds
s_waitcnt vmcnt(7)
s_add_u32 m0, s22, 82464
s_nop 0
buffer_load_dwordx4 v8, s[4:7], s81 offen offset:3072 nt lds
s_waitcnt vmcnt(7)
s_add_u32 m0, s22, 85568
s_nop 0
buffer_load_dwordx4 v8, s[4:7], s81 offen offset:1024 nt lds
s_waitcnt vmcnt(7)
s_add_u32 m0, s22, 85600
s_nop 0
buffer_load_dwordx4 v8, s[4:7], s81 offen offset:2048 nt lds
s_waitcnt vmcnt(7)
s_add_u32 m0, s22, 101376
s_nop 0
buffer_load_dwordx4 v8, s[4:7], s82 offen offset:0 nt lds
s_waitcnt vmcnt(7)
s_add_u32 m0, s22, 99360
s_nop 0
buffer_load_dwordx4 v8, s[4:7], s82 offen offset:3072 nt lds
s_waitcnt vmcnt(7)
s_add_u32 m0, s22, 102464
s_nop 0
buffer_load_dwordx4 v8, s[4:7], s82 offen offset:1024 nt lds
s_waitcnt vmcnt(7)
ds_read_b128 v[128:131], v40 offset:0
ds_read_b128 v[132:135], v41 offset:0
ds_read_b128 v[136:139], v42 offset:0
ds_read_b128 v[140:143], v43 offset:0
s_barrier
ds_read_b128 a[192:195], v6 offset:0
ds_read_b128 a[196:199], v6 offset:64
ds_read_b128 a[200:203], v6 offset:128
ds_read_b128 a[204:207], v6 offset:192
s_waitcnt vmcnt(7)
s_add_u32 m0, s22, 102496
s_nop 0
buffer_load_dwordx4 v8, s[4:7], s82 offen offset:2048 nt lds
s_waitcnt lgkmcnt(7)
v_lshlrev_b32 v20, 16, v128
v_and_b32 v21, 0xffff0000, v128
v_lshlrev_b32 v22, 16, v129
v_and_b32 v23, 0xffff0000, v129
v_lshlrev_b32 v24, 16, v130
v_and_b32 v25, 0xffff0000, v130
v_lshlrev_b32 v26, 16, v131
v_and_b32 v27, 0xffff0000, v131
v_pk_mul_f32 v[20:21], v[20:21], s[34:35]
v_pk_mul_f32 v[22:23], v[22:23], s[34:35]
v_pk_mul_f32 v[24:25], v[24:25], s[34:35]
v_pk_mul_f32 v[26:27], v[26:27], s[34:35]
v_cvt_pk_bf16_f32 v28, v20, v21
v_cvt_pk_bf16_f32 v29, v22, v23
v_cvt_pk_bf16_f32 v30, v24, v25
v_cvt_pk_bf16_f32 v31, v26, v27
v_accvgpr_write_b32 a128, v28
v_accvgpr_write_b32 a129, v29
v_accvgpr_write_b32 a130, v30
v_accvgpr_write_b32 a131, v31
s_waitcnt vmcnt(7)
s_add_u32 m0, s22, 118272
s_nop 0
buffer_load_dwordx4 v8, s[4:7], s83 offen offset:0 nt lds
s_waitcnt lgkmcnt(6)
v_lshlrev_b32 v20, 16, v132
v_and_b32 v21, 0xffff0000, v132
v_lshlrev_b32 v22, 16, v133
v_and_b32 v23, 0xffff0000, v133
v_lshlrev_b32 v24, 16, v134
v_and_b32 v25, 0xffff0000, v134
v_lshlrev_b32 v26, 16, v135
v_and_b32 v27, 0xffff0000, v135
v_pk_mul_f32 v[20:21], v[20:21], s[34:35]
v_pk_mul_f32 v[22:23], v[22:23], s[34:35]
v_pk_mul_f32 v[24:25], v[24:25], s[34:35]
v_pk_mul_f32 v[26:27], v[26:27], s[34:35]
v_cvt_pk_bf16_f32 v28, v20, v21
v_cvt_pk_bf16_f32 v29, v22, v23
v_cvt_pk_bf16_f32 v30, v24, v25
v_cvt_pk_bf16_f32 v31, v26, v27
v_accvgpr_write_b32 a132, v28
v_accvgpr_write_b32 a133, v29
v_accvgpr_write_b32 a134, v30
v_accvgpr_write_b32 a135, v31
s_waitcnt vmcnt(7)
s_add_u32 m0, s22, 116256
s_nop 0
buffer_load_dwordx4 v8, s[4:7], s83 offen offset:3072 nt lds
s_waitcnt lgkmcnt(5)
v_lshlrev_b32 v20, 16, v136
v_and_b32 v21, 0xffff0000, v136
v_lshlrev_b32 v22, 16, v137
v_and_b32 v23, 0xffff0000, v137
v_lshlrev_b32 v24, 16, v138
v_and_b32 v25, 0xffff0000, v138
v_lshlrev_b32 v26, 16, v139
v_and_b32 v27, 0xffff0000, v139
v_pk_mul_f32 v[20:21], v[20:21], s[34:35]
v_pk_mul_f32 v[22:23], v[22:23], s[34:35]
v_pk_mul_f32 v[24:25], v[24:25], s[34:35]
v_pk_mul_f32 v[26:27], v[26:27], s[34:35]
v_cvt_pk_bf16_f32 v28, v20, v21
v_cvt_pk_bf16_f32 v29, v22, v23
v_cvt_pk_bf16_f32 v30, v24, v25
v_cvt_pk_bf16_f32 v31, v26, v27
v_accvgpr_write_b32 a136, v28
v_accvgpr_write_b32 a137, v29
v_accvgpr_write_b32 a138, v30
v_accvgpr_write_b32 a139, v31
s_waitcnt vmcnt(7)
s_add_u32 m0, s22, 119360
s_nop 0
buffer_load_dwordx4 v8, s[4:7], s83 offen offset:1024 nt lds
s_waitcnt lgkmcnt(4)
v_lshlrev_b32 v20, 16, v140
v_and_b32 v21, 0xffff0000, v140
v_lshlrev_b32 v22, 16, v141
v_and_b32 v23, 0xffff0000, v141
v_lshlrev_b32 v24, 16, v142
v_and_b32 v25, 0xffff0000, v142
v_lshlrev_b32 v26, 16, v143
v_and_b32 v27, 0xffff0000, v143
v_pk_mul_f32 v[20:21], v[20:21], s[34:35]
v_pk_mul_f32 v[22:23], v[22:23], s[34:35]
v_pk_mul_f32 v[24:25], v[24:25], s[34:35]
v_pk_mul_f32 v[26:27], v[26:27], s[34:35]
v_cvt_pk_bf16_f32 v28, v20, v21
v_cvt_pk_bf16_f32 v29, v22, v23
v_cvt_pk_bf16_f32 v30, v24, v25
v_cvt_pk_bf16_f32 v31, v26, v27
v_accvgpr_write_b32 a140, v28
v_accvgpr_write_b32 a141, v29
v_accvgpr_write_b32 a142, v30
v_accvgpr_write_b32 a143, v31
s_waitcnt vmcnt(7)
ds_read_b128 v[128:131], v40 offset:16896
ds_read_b128 v[132:135], v41 offset:16896
ds_read_b128 v[136:139], v42 offset:16896
ds_read_b128 v[140:143], v43 offset:16896
s_waitcnt vmcnt(7)
s_add_u32 m0, s22, 119392
s_nop 0
buffer_load_dwordx4 v8, s[4:7], s83 offen offset:2048 nt lds
s_waitcnt lgkmcnt(3)
v_lshlrev_b32 v20, 16, v128
v_and_b32 v21, 0xffff0000, v128
v_lshlrev_b32 v22, 16, v129
v_and_b32 v23, 0xffff0000, v129
v_lshlrev_b32 v24, 16, v130
v_and_b32 v25, 0xffff0000, v130
v_lshlrev_b32 v26, 16, v131
v_and_b32 v27, 0xffff0000, v131
v_pk_mul_f32 v[20:21], v[20:21], s[34:35]
v_pk_mul_f32 v[22:23], v[22:23], s[34:35]
v_pk_mul_f32 v[24:25], v[24:25], s[34:35]
v_pk_mul_f32 v[26:27], v[26:27], s[34:35]
v_cvt_pk_bf16_f32 v28, v20, v21
v_cvt_pk_bf16_f32 v29, v22, v23
v_cvt_pk_bf16_f32 v30, v24, v25
v_cvt_pk_bf16_f32 v31, v26, v27
v_accvgpr_write_b32 a144, v28
v_accvgpr_write_b32 a145, v29
v_accvgpr_write_b32 a146, v30
v_accvgpr_write_b32 a147, v31
s_waitcnt vmcnt(7)
s_add_u32 m0, s22, 16896
s_nop 0
buffer_load_dwordx4 v2, s[8:11], s20 offen offset:0 nt lds
s_waitcnt lgkmcnt(2)
v_lshlrev_b32 v20, 16, v132
v_and_b32 v21, 0xffff0000, v132
v_lshlrev_b32 v22, 16, v133
v_and_b32 v23, 0xffff0000, v133
v_lshlrev_b32 v24, 16, v134
v_and_b32 v25, 0xffff0000, v134
v_lshlrev_b32 v26, 16, v135
v_and_b32 v27, 0xffff0000, v135
v_pk_mul_f32 v[20:21], v[20:21], s[34:35]
v_pk_mul_f32 v[22:23], v[22:23], s[34:35]
v_pk_mul_f32 v[24:25], v[24:25], s[34:35]
v_pk_mul_f32 v[26:27], v[26:27], s[34:35]
v_cvt_pk_bf16_f32 v28, v20, v21
v_cvt_pk_bf16_f32 v29, v22, v23
v_cvt_pk_bf16_f32 v30, v24, v25
v_cvt_pk_bf16_f32 v31, v26, v27
v_accvgpr_write_b32 a148, v28
v_accvgpr_write_b32 a149, v29
v_accvgpr_write_b32 a150, v30
v_accvgpr_write_b32 a151, v31
s_waitcnt vmcnt(7)
buffer_load_dwordx4 v3, s[8:11], s20 offen offset:1056 nt lds
s_waitcnt lgkmcnt(1)
v_lshlrev_b32 v20, 16, v136
v_and_b32 v21, 0xffff0000, v136
v_lshlrev_b32 v22, 16, v137
v_and_b32 v23, 0xffff0000, v137
v_lshlrev_b32 v24, 16, v138
v_and_b32 v25, 0xffff0000, v138
v_lshlrev_b32 v26, 16, v139
v_and_b32 v27, 0xffff0000, v139
v_pk_mul_f32 v[20:21], v[20:21], s[34:35]
v_pk_mul_f32 v[22:23], v[22:23], s[34:35]
v_pk_mul_f32 v[24:25], v[24:25], s[34:35]
v_pk_mul_f32 v[26:27], v[26:27], s[34:35]
v_cvt_pk_bf16_f32 v28, v20, v21
v_cvt_pk_bf16_f32 v29, v22, v23
v_cvt_pk_bf16_f32 v30, v24, v25
v_cvt_pk_bf16_f32 v31, v26, v27
v_accvgpr_write_b32 a152, v28
v_accvgpr_write_b32 a153, v29
v_accvgpr_write_b32 a154, v30
v_accvgpr_write_b32 a155, v31
s_waitcnt vmcnt(7)
buffer_load_dwordx4 v4, s[8:11], s20 offen offset:2112 nt lds
s_waitcnt lgkmcnt(0)
v_lshlrev_b32 v20, 16, v140
v_and_b32 v21, 0xffff0000, v140
v_lshlrev_b32 v22, 16, v141
v_and_b32 v23, 0xffff0000, v141
v_lshlrev_b32 v24, 16, v142
v_and_b32 v25, 0xffff0000, v142
v_lshlrev_b32 v26, 16, v143
v_and_b32 v27, 0xffff0000, v143
v_pk_mul_f32 v[20:21], v[20:21], s[34:35]
v_pk_mul_f32 v[22:23], v[22:23], s[34:35]
v_pk_mul_f32 v[24:25], v[24:25], s[34:35]
v_pk_mul_f32 v[26:27], v[26:27], s[34:35]
v_cvt_pk_bf16_f32 v28, v20, v21
v_cvt_pk_bf16_f32 v29, v22, v23
v_cvt_pk_bf16_f32 v30, v24, v25
v_cvt_pk_bf16_f32 v31, v26, v27
v_accvgpr_write_b32 a156, v28
v_accvgpr_write_b32 a157, v29
v_accvgpr_write_b32 a158, v30
v_accvgpr_write_b32 a159, v31
s_waitcnt vmcnt(7)
ds_read_b128 v[128:131], v40 offset:33792
ds_read_b128 v[132:135], v41 offset:33792
ds_read_b128 v[136:139], v42 offset:33792
ds_read_b128 v[140:143], v43 offset:33792
s_waitcnt vmcnt(7)
buffer_load_dwordx4 v5, s[8:11], s20 offen offset:3168 nt lds
s_xor_b32 s20, s20, 24576
s_waitcnt lgkmcnt(3)
v_lshlrev_b32 v20, 16, v128
v_and_b32 v21, 0xffff0000, v128
v_lshlrev_b32 v22, 16, v129
v_and_b32 v23, 0xffff0000, v129
v_lshlrev_b32 v24, 16, v130
v_and_b32 v25, 0xffff0000, v130
v_lshlrev_b32 v26, 16, v131
v_and_b32 v27, 0xffff0000, v131
v_pk_mul_f32 v[20:21], v[20:21], s[34:35]
v_pk_mul_f32 v[22:23], v[22:23], s[34:35]
v_pk_mul_f32 v[24:25], v[24:25], s[34:35]
v_pk_mul_f32 v[26:27], v[26:27], s[34:35]
v_cvt_pk_bf16_f32 v28, v20, v21
v_cvt_pk_bf16_f32 v29, v22, v23
v_cvt_pk_bf16_f32 v30, v24, v25
v_cvt_pk_bf16_f32 v31, v26, v27
v_accvgpr_write_b32 a160, v28
v_accvgpr_write_b32 a161, v29
v_accvgpr_write_b32 a162, v30
v_accvgpr_write_b32 a163, v31
s_waitcnt vmcnt(7)
s_add_u32 m0, s22, 33792
s_nop 0
buffer_load_dwordx4 v2, s[8:11], s20 offen offset:0 nt lds
s_waitcnt lgkmcnt(2)
v_lshlrev_b32 v20, 16, v132
v_and_b32 v21, 0xffff0000, v132
v_lshlrev_b32 v22, 16, v133
v_and_b32 v23, 0xffff0000, v133
v_lshlrev_b32 v24, 16, v134
v_and_b32 v25, 0xffff0000, v134
v_lshlrev_b32 v26, 16, v135
v_and_b32 v27, 0xffff0000, v135
v_pk_mul_f32 v[20:21], v[20:21], s[34:35]
v_pk_mul_f32 v[22:23], v[22:23], s[34:35]
v_pk_mul_f32 v[24:25], v[24:25], s[34:35]
v_pk_mul_f32 v[26:27], v[26:27], s[34:35]
v_cvt_pk_bf16_f32 v28, v20, v21
v_cvt_pk_bf16_f32 v29, v22, v23
v_cvt_pk_bf16_f32 v30, v24, v25
v_cvt_pk_bf16_f32 v31, v26, v27
v_accvgpr_write_b32 a164, v28
v_accvgpr_write_b32 a165, v29
v_accvgpr_write_b32 a166, v30
v_accvgpr_write_b32 a167, v31
s_waitcnt vmcnt(7)
buffer_load_dwordx4 v3, s[8:11], s20 offen offset:1056 nt lds
s_waitcnt lgkmcnt(1)
v_lshlrev_b32 v20, 16, v136
v_and_b32 v21, 0xffff0000, v136
v_lshlrev_b32 v22, 16, v137
v_and_b32 v23, 0xffff0000, v137
v_lshlrev_b32 v24, 16, v138
v_and_b32 v25, 0xffff0000, v138
v_lshlrev_b32 v26, 16, v139
v_and_b32 v27, 0xffff0000, v139
v_pk_mul_f32 v[20:21], v[20:21], s[34:35]
v_pk_mul_f32 v[22:23], v[22:23], s[34:35]
v_pk_mul_f32 v[24:25], v[24:25], s[34:35]
v_pk_mul_f32 v[26:27], v[26:27], s[34:35]
v_cvt_pk_bf16_f32 v28, v20, v21
v_cvt_pk_bf16_f32 v29, v22, v23
v_cvt_pk_bf16_f32 v30, v24, v25
v_cvt_pk_bf16_f32 v31, v26, v27
v_accvgpr_write_b32 a168, v28
v_accvgpr_write_b32 a169, v29
v_accvgpr_write_b32 a170, v30
v_accvgpr_write_b32 a171, v31
s_waitcnt lgkmcnt(0)
v_lshlrev_b32 v20, 16, v140
v_and_b32 v21, 0xffff0000, v140
v_lshlrev_b32 v22, 16, v141
v_and_b32 v23, 0xffff0000, v141
v_lshlrev_b32 v24, 16, v142
v_and_b32 v25, 0xffff0000, v142
v_lshlrev_b32 v26, 16, v143
v_and_b32 v27, 0xffff0000, v143
v_pk_mul_f32 v[20:21], v[20:21], s[34:35]
v_pk_mul_f32 v[22:23], v[22:23], s[34:35]
v_pk_mul_f32 v[24:25], v[24:25], s[34:35]
v_pk_mul_f32 v[26:27], v[26:27], s[34:35]
v_cvt_pk_bf16_f32 v28, v20, v21
v_cvt_pk_bf16_f32 v29, v22, v23
v_cvt_pk_bf16_f32 v30, v24, v25
v_cvt_pk_bf16_f32 v31, v26, v27
v_accvgpr_write_b32 a172, v28
v_accvgpr_write_b32 a173, v29
v_accvgpr_write_b32 a174, v30
v_accvgpr_write_b32 a175, v31
s_waitcnt vmcnt(6)
ds_read_b128 v[128:131], v40 offset:50688
ds_read_b128 v[132:135], v41 offset:50688
ds_read_b128 v[136:139], v42 offset:50688
ds_read_b128 v[140:143], v43 offset:50688
s_waitcnt lgkmcnt(3)
v_lshlrev_b32 v20, 16, v128
v_and_b32 v21, 0xffff0000, v128
v_lshlrev_b32 v22, 16, v129
v_and_b32 v23, 0xffff0000, v129
v_lshlrev_b32 v24, 16, v130
v_and_b32 v25, 0xffff0000, v130
v_lshlrev_b32 v26, 16, v131
v_and_b32 v27, 0xffff0000, v131
v_pk_mul_f32 v[20:21], v[20:21], s[34:35]
v_pk_mul_f32 v[22:23], v[22:23], s[34:35]
v_pk_mul_f32 v[24:25], v[24:25], s[34:35]
v_pk_mul_f32 v[26:27], v[26:27], s[34:35]
v_cvt_pk_bf16_f32 v28, v20, v21
v_cvt_pk_bf16_f32 v29, v22, v23
v_cvt_pk_bf16_f32 v30, v24, v25
v_cvt_pk_bf16_f32 v31, v26, v27
v_accvgpr_write_b32 a176, v28
v_accvgpr_write_b32 a177, v29
v_accvgpr_write_b32 a178, v30
v_accvgpr_write_b32 a179, v31
s_waitcnt lgkmcnt(2)
v_lshlrev_b32 v20, 16, v132
v_and_b32 v21, 0xffff0000, v132
v_lshlrev_b32 v22, 16, v133
v_and_b32 v23, 0xffff0000, v133
v_lshlrev_b32 v24, 16, v134
v_and_b32 v25, 0xffff0000, v134
v_lshlrev_b32 v26, 16, v135
v_and_b32 v27, 0xffff0000, v135
v_pk_mul_f32 v[20:21], v[20:21], s[34:35]
v_pk_mul_f32 v[22:23], v[22:23], s[34:35]
v_pk_mul_f32 v[24:25], v[24:25], s[34:35]
v_pk_mul_f32 v[26:27], v[26:27], s[34:35]
v_cvt_pk_bf16_f32 v28, v20, v21
v_cvt_pk_bf16_f32 v29, v22, v23
v_cvt_pk_bf16_f32 v30, v24, v25
v_cvt_pk_bf16_f32 v31, v26, v27
v_accvgpr_write_b32 a180, v28
v_accvgpr_write_b32 a181, v29
v_accvgpr_write_b32 a182, v30
v_accvgpr_write_b32 a183, v31
s_waitcnt lgkmcnt(1)
v_lshlrev_b32 v20, 16, v136
v_and_b32 v21, 0xffff0000, v136
v_lshlrev_b32 v22, 16, v137
v_and_b32 v23, 0xffff0000, v137
v_lshlrev_b32 v24, 16, v138
v_and_b32 v25, 0xffff0000, v138
v_lshlrev_b32 v26, 16, v139
v_and_b32 v27, 0xffff0000, v139
v_pk_mul_f32 v[20:21], v[20:21], s[34:35]
v_pk_mul_f32 v[22:23], v[22:23], s[34:35]
v_pk_mul_f32 v[24:25], v[24:25], s[34:35]
v_pk_mul_f32 v[26:27], v[26:27], s[34:35]
v_cvt_pk_bf16_f32 v28, v20, v21
v_cvt_pk_bf16_f32 v29, v22, v23
v_cvt_pk_bf16_f32 v30, v24, v25
v_cvt_pk_bf16_f32 v31, v26, v27
v_accvgpr_write_b32 a184, v28
v_accvgpr_write_b32 a185, v29
v_accvgpr_write_b32 a186, v30
v_accvgpr_write_b32 a187, v31
s_waitcnt lgkmcnt(0)
v_lshlrev_b32 v20, 16, v140
v_and_b32 v21, 0xffff0000, v140
v_lshlrev_b32 v22, 16, v141
v_and_b32 v23, 0xffff0000, v141
v_lshlrev_b32 v24, 16, v142
v_and_b32 v25, 0xffff0000, v142
v_lshlrev_b32 v26, 16, v143
v_and_b32 v27, 0xffff0000, v143
v_pk_mul_f32 v[20:21], v[20:21], s[34:35]
v_pk_mul_f32 v[22:23], v[22:23], s[34:35]
v_pk_mul_f32 v[24:25], v[24:25], s[34:35]
v_pk_mul_f32 v[26:27], v[26:27], s[34:35]
v_cvt_pk_bf16_f32 v28, v20, v21
v_cvt_pk_bf16_f32 v29, v22, v23
v_cvt_pk_bf16_f32 v30, v24, v25
v_cvt_pk_bf16_f32 v31, v26, v27
v_accvgpr_write_b32 a188, v28
v_accvgpr_write_b32 a189, v29
v_accvgpr_write_b32 a190, v30
v_accvgpr_write_b32 a191, v31
s_waitcnt lgkmcnt(0)
v_mfma_f32_16x16x32_bf16 v[48:51], a[192:195], a[128:131], 0
v_mfma_f32_16x16x32_bf16 v[48:51], a[196:199], a[132:135], v[48:51]
v_mfma_f32_16x16x32_bf16 v[48:51], a[200:203], a[136:139], v[48:51]
v_mfma_f32_16x16x32_bf16 v[48:51], a[204:207], a[140:143], v[48:51]
v_mfma_f32_16x16x32_bf16 v[52:55], a[192:195], a[144:147], 0
v_mfma_f32_16x16x32_bf16 v[52:55], a[196:199], a[148:151], v[52:55]
v_mfma_f32_16x16x32_bf16 v[52:55], a[200:203], a[152:155], v[52:55]
v_mfma_f32_16x16x32_bf16 v[52:55], a[204:207], a[156:159], v[52:55]
v_mfma_f32_16x16x32_bf16 v[56:59], a[192:195], a[160:163], 0
v_mfma_f32_16x16x32_bf16 v[56:59], a[196:199], a[164:167], v[56:59]
v_mfma_f32_16x16x32_bf16 v[56:59], a[200:203], a[168:171], v[56:59]
v_mfma_f32_16x16x32_bf16 v[56:59], a[204:207], a[172:175], v[56:59]
v_mfma_f32_16x16x32_bf16 v[60:63], a[192:195], a[176:179], 0
v_mfma_f32_16x16x32_bf16 v[60:63], a[196:199], a[180:183], v[60:63]
v_mfma_f32_16x16x32_bf16 v[60:63], a[200:203], a[184:187], v[60:63]
v_mfma_f32_16x16x32_bf16 v[60:63], a[204:207], a[188:191], v[60:63]
s_nop 4
v_max3_f32 v16, v16, v48, v49
v_max3_f32 v17, v17, v52, v53
v_max3_f32 v18, v18, v56, v57
v_max3_f32 v19, v19, v60, v61
v_max3_f32 v16, v16, v50, v51
v_max3_f32 v17, v17, v54, v55
v_max3_f32 v18, v18, v58, v59
v_max3_f32 v19, v19, v62, v63
v_mov_b32 v20, v16
v_mov_b32 v21, v17
v_mov_b32 v22, v18
v_mov_b32 v23, v19
v_permlane32_swap_b32 v20, v16
v_permlane32_swap_b32 v21, v17
v_permlane32_swap_b32 v22, v18
v_permlane32_swap_b32 v23, v19
v_max_f32 v16, v16, v20
v_max_f32 v17, v17, v21
v_max_f32 v18, v18, v22
v_max_f32 v19, v19, v23
v_mov_b32 v20, v16
v_mov_b32 v21, v17
v_mov_b32 v22, v18
v_mov_b32 v23, v19
v_permlane16_swap_b32 v20, v16
v_permlane16_swap_b32 v21, v17
v_permlane16_swap_b32 v22, v18
v_permlane16_swap_b32 v23, v19
v_max_f32 v16, v16, v20
v_max_f32 v17, v17, v21
v_max_f32 v18, v18, v22
v_max_f32 v19, v19, v23
s_mov_b32 s36, 0xc1200000
v_sub_f32 v64, s36, v16
v_sub_f32 v68, s36, v17
v_sub_f32 v72, s36, v18
v_sub_f32 v76, s36, v19
v_mov_b32 v65, v64
v_mov_b32 v66, v64
v_mov_b32 v67, v64
v_mov_b32 v69, v68
v_mov_b32 v70, v68
v_mov_b32 v71, v68
v_mov_b32 v73, v72
v_mov_b32 v74, v72
v_mov_b32 v75, v72
v_mov_b32 v77, v76
v_mov_b32 v78, v76
v_mov_b32 v79, v76
s_nop 0
v_mfma_f32_16x16x32_bf16 v[48:51], a[192:195], a[128:131], v[64:67]
ds_read_b128 a[208:211], v6 offset:256
v_mfma_f32_16x16x32_bf16 v[48:51], a[196:199], a[132:135], v[48:51]
v_mfma_f32_16x16x32_bf16 v[48:51], a[200:203], a[136:139], v[48:51]
ds_read_b128 a[212:215], v6 offset:320
v_mfma_f32_16x16x32_bf16 v[48:51], a[204:207], a[140:143], v[48:51]
s_waitcnt vmcnt(4)
buffer_load_dwordx4 v4, s[8:11], s20 offen offset:2112 nt lds
v_mfma_f32_16x16x32_bf16 v[52:55], a[204:207], a[156:159], v[68:71]
ds_read_b128 a[216:219], v6 offset:384
v_mfma_f32_16x16x32_bf16 v[52:55], a[200:203], a[152:155], v[52:55]
v_mfma_f32_16x16x32_bf16 v[52:55], a[196:199], a[148:151], v[52:55]
ds_read_b128 a[220:223], v6 offset:448
s_nop 0
v_exp_f32 v48, v48
v_mfma_f32_16x16x32_bf16 v[52:55], a[192:195], a[144:147], v[52:55]
v_exp_f32 v49, v49
v_mfma_f32_16x16x32_bf16 v[56:59], a[192:195], a[160:163], v[72:75]
v_exp_f32 v50, v50
v_perm_b32 v128, v49, v48, s84
v_mfma_f32_16x16x32_bf16 v[56:59], a[196:199], a[164:167], v[56:59]
v_exp_f32 v51, v51
v_mfma_f32_16x16x32_bf16 v[56:59], a[200:203], a[168:171], v[56:59]
v_perm_b32 v129, v51, v50, s84
v_exp_f32 v52, v52
v_mfma_f32_16x16x32_bf16 v[56:59], a[204:207], a[172:175], v[56:59]
s_waitcnt vmcnt(4)
buffer_load_dwordx4 v5, s[8:11], s20 offen offset:3168 nt lds
v_exp_f32 v53, v53
v_mfma_f32_16x16x32_bf16 v[60:63], a[204:207], a[188:191], v[76:79]
s_xor_b32 s20, s20, 8192
v_exp_f32 v54, v54
v_perm_b32 v144, v53, v52, s84
v_mfma_f32_16x16x32_bf16 v[60:63], a[200:203], a[184:187], v[60:63]
v_exp_f32 v55, v55
v_mfma_f32_16x16x32_bf16 v[60:63], a[196:199], a[180:183], v[60:63]
v_perm_b32 v145, v55, v54, s84
v_exp_f32 v56, v56
v_mfma_f32_16x16x32_bf16 v[60:63], a[192:195], a[176:179], v[60:63]
s_waitcnt lgkmcnt(0)
v_exp_f32 v57, v57
v_mfma_f32_16x16x32_bf16 v[48:51], a[208:211], a[128:131], v[64:67]
ds_read_b128 a[192:195], v6 offset:512
v_exp_f32 v58, v58
v_perm_b32 v160, v57, v56, s84
v_mfma_f32_16x16x32_bf16 v[48:51], a[212:215], a[132:135], v[48:51]
v_exp_f32 v59, v59
v_mfma_f32_16x16x32_bf16 v[48:51], a[216:219], a[136:139], v[48:51]
s_add_u32 m0, s22, 67584
ds_read_b128 a[196:199], v6 offset:576
v_perm_b32 v161, v59, v58, s84
v_exp_f32 v60, v60
v_mfma_f32_16x16x32_bf16 v[48:51], a[220:223], a[140:143], v[48:51]
s_waitcnt vmcnt(4)
buffer_load_dwordx4 v2, s[12:15], s21 offen offset:0 nt lds
v_exp_f32 v61, v61
v_mfma_f32_16x16x32_bf16 v[52:55], a[220:223], a[156:159], v[68:71]
ds_read_b128 a[200:203], v6 offset:640
v_exp_f32 v62, v62
v_perm_b32 v176, v61, v60, s84
v_mfma_f32_16x16x32_bf16 v[52:55], a[216:219], a[152:155], v[52:55]
v_exp_f32 v63, v63
v_mfma_f32_16x16x32_bf16 v[52:55], a[212:215], a[148:151], v[52:55]
ds_read_b128 a[204:207], v6 offset:704
v_perm_b32 v177, v63, v62, s84
v_exp_f32 v48, v48
v_mfma_f32_16x16x32_bf16 v[52:55], a[208:211], a[144:147], v[52:55]
v_exp_f32 v49, v49
v_mfma_f32_16x16x32_bf16 v[56:59], a[208:211], a[160:163], v[72:75]
v_exp_f32 v50, v50
v_perm_b32 v130, v49, v48, s84
v_mfma_f32_16x16x32_bf16 v[56:59], a[212:215], a[164:167], v[56:59]
v_exp_f32 v51, v51
v_mfma_f32_16x16x32_bf16 v[56:59], a[216:219], a[168:171], v[56:59]
v_perm_b32 v131, v51, v50, s84
v_exp_f32 v52, v52
v_mfma_f32_16x16x32_bf16 v[56:59], a[220:223], a[172:175], v[56:59]
s_waitcnt vmcnt(4)
buffer_load_dwordx4 v3, s[12:15], s21 offen offset:1056 nt lds
v_exp_f32 v53, v53
v_mfma_f32_16x16x32_bf16 v[60:63], a[220:223], a[188:191], v[76:79]
v_exp_f32 v54, v54
v_perm_b32 v146, v53, v52, s84
v_mfma_f32_16x16x32_bf16 v[60:63], a[216:219], a[184:187], v[60:63]
v_exp_f32 v55, v55
v_mfma_f32_16x16x32_bf16 v[60:63], a[212:215], a[180:183], v[60:63]
v_perm_b32 v147, v55, v54, s84
v_exp_f32 v56, v56
v_mfma_f32_16x16x32_bf16 v[60:63], a[208:211], a[176:179], v[60:63]
s_waitcnt lgkmcnt(0)
v_exp_f32 v57, v57
v_mfma_f32_16x16x32_bf16 v[48:51], a[192:195], a[128:131], v[64:67]
ds_read_b128 a[208:211], v6 offset:768
v_exp_f32 v58, v58
v_perm_b32 v162, v57, v56, s84
v_mfma_f32_16x16x32_bf16 v[48:51], a[196:199], a[132:135], v[48:51]
v_exp_f32 v59, v59
v_mfma_f32_16x16x32_bf16 v[48:51], a[200:203], a[136:139], v[48:51]
ds_read_b128 a[212:215], v6 offset:832
v_perm_b32 v163, v59, v58, s84
v_exp_f32 v60, v60
v_mfma_f32_16x16x32_bf16 v[48:51], a[204:207], a[140:143], v[48:51]
s_waitcnt vmcnt(4)
buffer_load_dwordx4 v4, s[12:15], s21 offen offset:2112 nt lds
v_exp_f32 v61, v61
v_mfma_f32_16x16x32_bf16 v[52:55], a[204:207], a[156:159], v[68:71]
ds_read_b128 a[216:219], v6 offset:896
v_exp_f32 v62, v62
v_perm_b32 v178, v61, v60, s84
v_mfma_f32_16x16x32_bf16 v[52:55], a[200:203], a[152:155], v[52:55]
v_exp_f32 v63, v63
v_mfma_f32_16x16x32_bf16 v[52:55], a[196:199], a[148:151], v[52:55]
ds_read_b128 a[220:223], v6 offset:960
v_perm_b32 v179, v63, v62, s84
v_exp_f32 v48, v48
v_mfma_f32_16x16x32_bf16 v[52:55], a[192:195], a[144:147], v[52:55]
v_exp_f32 v49, v49
v_mfma_f32_16x16x32_bf16 v[56:59], a[192:195], a[160:163], v[72:75]
v_exp_f32 v50, v50
v_perm_b32 v132, v49, v48, s84
v_mfma_f32_16x16x32_bf16 v[56:59], a[196:199], a[164:167], v[56:59]
v_exp_f32 v51, v51
v_mfma_f32_16x16x32_bf16 v[56:59], a[200:203], a[168:171], v[56:59]
v_perm_b32 v133, v51, v50, s84
v_exp_f32 v52, v52
v_mfma_f32_16x16x32_bf16 v[56:59], a[204:207], a[172:175], v[56:59]
s_waitcnt vmcnt(4)
buffer_load_dwordx4 v5, s[12:15], s21 offen offset:3168 nt lds
v_exp_f32 v53, v53
v_mfma_f32_16x16x32_bf16 v[60:63], a[204:207], a[188:191], v[76:79]
s_xor_b32 s21, s21, 8192
v_exp_f32 v54, v54
v_perm_b32 v148, v53, v52, s84
v_mfma_f32_16x16x32_bf16 v[60:63], a[200:203], a[184:187], v[60:63]
v_exp_f32 v55, v55
v_mfma_f32_16x16x32_bf16 v[60:63], a[196:199], a[180:183], v[60:63]
v_perm_b32 v149, v55, v54, s84
v_exp_f32 v56, v56
v_mfma_f32_16x16x32_bf16 v[60:63], a[192:195], a[176:179], v[60:63]
s_waitcnt vmcnt(8) lgkmcnt(0)
v_exp_f32 v57, v57
v_mfma_f32_16x16x32_bf16 v[48:51], a[208:211], a[128:131], v[64:67]
s_barrier
ds_read_b128 a[192:195], v6 offset:16896
v_exp_f32 v58, v58
v_perm_b32 v164, v57, v56, s84
v_mfma_f32_16x16x32_bf16 v[48:51], a[212:215], a[132:135], v[48:51]
v_exp_f32 v59, v59
v_mfma_f32_16x16x32_bf16 v[48:51], a[216:219], a[136:139], v[48:51]
s_add_u32 m0, s22, 84480
ds_read_b128 a[196:199], v6 offset:16960
v_perm_b32 v165, v59, v58, s84
v_exp_f32 v60, v60
v_mfma_f32_16x16x32_bf16 v[48:51], a[220:223], a[140:143], v[48:51]
s_waitcnt vmcnt(4)
buffer_load_dwordx4 v2, s[12:15], s21 offen offset:0 nt lds
v_exp_f32 v61, v61
v_mfma_f32_16x16x32_bf16 v[52:55], a[220:223], a[156:159], v[68:71]
ds_read_b128 a[200:203], v6 offset:17024
v_exp_f32 v62, v62
v_perm_b32 v180, v61, v60, s84
v_mfma_f32_16x16x32_bf16 v[52:55], a[216:219], a[152:155], v[52:55]
v_exp_f32 v63, v63
v_mfma_f32_16x16x32_bf16 v[52:55], a[212:215], a[148:151], v[52:55]
ds_read_b128 a[204:207], v6 offset:17088
v_perm_b32 v181, v63, v62, s84
v_exp_f32 v48, v48
v_mfma_f32_16x16x32_bf16 v[52:55], a[208:211], a[144:147], v[52:55]
v_exp_f32 v49, v49
v_mfma_f32_16x16x32_bf16 v[56:59], a[208:211], a[160:163], v[72:75]
v_exp_f32 v50, v50
v_perm_b32 v134, v49, v48, s84
v_mfma_f32_16x16x32_bf16 v[56:59], a[212:215], a[164:167], v[56:59]
v_exp_f32 v51, v51
v_mfma_f32_16x16x32_bf16 v[56:59], a[216:219], a[168:171], v[56:59]
v_perm_b32 v135, v51, v50, s84
v_exp_f32 v52, v52
v_mfma_f32_16x16x32_bf16 v[56:59], a[220:223], a[172:175], v[56:59]
s_waitcnt vmcnt(4)
buffer_load_dwordx4 v3, s[12:15], s21 offen offset:1056 nt lds
v_exp_f32 v53, v53
v_mfma_f32_16x16x32_bf16 v[60:63], a[220:223], a[188:191], v[76:79]
v_exp_f32 v54, v54
v_perm_b32 v150, v53, v52, s84
v_mfma_f32_16x16x32_bf16 v[60:63], a[216:219], a[184:187], v[60:63]
v_exp_f32 v55, v55
v_mfma_f32_16x16x32_bf16 v[60:63], a[212:215], a[180:183], v[60:63]
v_perm_b32 v151, v55, v54, s84
v_exp_f32 v56, v56
v_mfma_f32_16x16x32_bf16 v[60:63], a[208:211], a[176:179], v[60:63]
s_waitcnt lgkmcnt(0)
v_exp_f32 v57, v57
v_mfma_f32_16x16x32_bf16 v[48:51], a[192:195], a[128:131], v[64:67]
ds_read_b128 a[208:211], v6 offset:17152
v_exp_f32 v58, v58
v_perm_b32 v166, v57, v56, s84
v_mfma_f32_16x16x32_bf16 v[48:51], a[196:199], a[132:135], v[48:51]
v_exp_f32 v59, v59
v_mfma_f32_16x16x32_bf16 v[48:51], a[200:203], a[136:139], v[48:51]
ds_read_b128 a[212:215], v6 offset:17216
v_perm_b32 v167, v59, v58, s84
v_exp_f32 v60, v60
v_mfma_f32_16x16x32_bf16 v[48:51], a[204:207], a[140:143], v[48:51]
s_waitcnt vmcnt(4)
buffer_load_dwordx4 v4, s[12:15], s21 offen offset:2112 nt lds
v_exp_f32 v61, v61
v_mfma_f32_16x16x32_bf16 v[52:55], a[204:207], a[156:159], v[68:71]
ds_read_b128 a[216:219], v6 offset:17280
v_exp_f32 v62, v62
v_perm_b32 v182, v61, v60, s84
v_mfma_f32_16x16x32_bf16 v[52:55], a[200:203], a[152:155], v[52:55]
v_exp_f32 v63, v63
v_mfma_f32_16x16x32_bf16 v[52:55], a[196:199], a[148:151], v[52:55]
ds_read_b128 a[220:223], v6 offset:17344
v_perm_b32 v183, v63, v62, s84
v_exp_f32 v48, v48
v_mfma_f32_16x16x32_bf16 v[52:55], a[192:195], a[144:147], v[52:55]
v_exp_f32 v49, v49
v_mfma_f32_16x16x32_bf16 v[56:59], a[192:195], a[160:163], v[72:75]
v_exp_f32 v50, v50
v_perm_b32 v136, v49, v48, s84
v_mfma_f32_16x16x32_bf16 v[56:59], a[196:199], a[164:167], v[56:59]
v_exp_f32 v51, v51
v_mfma_f32_16x16x32_bf16 v[56:59], a[200:203], a[168:171], v[56:59]
v_perm_b32 v137, v51, v50, s84
v_exp_f32 v52, v52
v_mfma_f32_16x16x32_bf16 v[56:59], a[204:207], a[172:175], v[56:59]
s_waitcnt vmcnt(4)
buffer_load_dwordx4 v5, s[12:15], s21 offen offset:3168 nt lds
v_exp_f32 v53, v53
v_mfma_f32_16x16x32_bf16 v[60:63], a[204:207], a[188:191], v[76:79]
s_xor_b32 s21, s21, 24576
v_exp_f32 v54, v54
v_perm_b32 v152, v53, v52, s84
v_mfma_f32_16x16x32_bf16 v[60:63], a[200:203], a[184:187], v[60:63]
v_exp_f32 v55, v55
v_mfma_f32_16x16x32_bf16 v[60:63], a[196:199], a[180:183], v[60:63]
v_perm_b32 v153, v55, v54, s84
v_exp_f32 v56, v56
v_mfma_f32_16x16x32_bf16 v[60:63], a[192:195], a[176:179], v[60:63]
s_waitcnt lgkmcnt(0)
v_exp_f32 v57, v57
v_mfma_f32_16x16x32_bf16 v[48:51], a[208:211], a[128:131], v[64:67]
ds_read_b128 a[192:195], v6 offset:17408
v_exp_f32 v58, v58
v_perm_b32 v168, v57, v56, s84
v_mfma_f32_16x16x32_bf16 v[48:51], a[212:215], a[132:135], v[48:51]
v_exp_f32 v59, v59
v_mfma_f32_16x16x32_bf16 v[48:51], a[216:219], a[136:139], v[48:51]
s_add_u32 m0, s22, 50688
ds_read_b128 a[196:199], v6 offset:17472
v_perm_b32 v169, v59, v58, s84
v_exp_f32 v60, v60
v_mfma_f32_16x16x32_bf16 v[48:51], a[220:223], a[140:143], v[48:51]
s_waitcnt vmcnt(4)
buffer_load_dwordx4 v2, s[8:11], s20 offen offset:0 nt lds
v_exp_f32 v61, v61
v_mfma_f32_16x16x32_bf16 v[52:55], a[220:223], a[156:159], v[68:71]
ds_read_b128 a[200:203], v6 offset:17536
v_exp_f32 v62, v62
v_perm_b32 v184, v61, v60, s84
v_mfma_f32_16x16x32_bf16 v[52:55], a[216:219], a[152:155], v[52:55]
v_exp_f32 v63, v63
v_mfma_f32_16x16x32_bf16 v[52:55], a[212:215], a[148:151], v[52:55]
ds_read_b128 a[204:207], v6 offset:17600
v_perm_b32 v185, v63, v62, s84
v_exp_f32 v48, v48
v_mfma_f32_16x16x32_bf16 v[52:55], a[208:211], a[144:147], v[52:55]
v_exp_f32 v49, v49
v_mfma_f32_16x16x32_bf16 v[56:59], a[208:211], a[160:163], v[72:75]
v_exp_f32 v50, v50
v_perm_b32 v138, v49, v48, s84
v_mfma_f32_16x16x32_bf16 v[56:59], a[212:215], a[164:167], v[56:59]
v_exp_f32 v51, v51
v_mfma_f32_16x16x32_bf16 v[56:59], a[216:219], a[168:171], v[56:59]
v_perm_b32 v139, v51, v50, s84
v_exp_f32 v52, v52
v_mfma_f32_16x16x32_bf16 v[56:59], a[220:223], a[172:175], v[56:59]
s_waitcnt vmcnt(4)
buffer_load_dwordx4 v3, s[8:11], s20 offen offset:1056 nt lds
v_exp_f32 v53, v53
v_mfma_f32_16x16x32_bf16 v[60:63], a[220:223], a[188:191], v[76:79]
v_exp_f32 v54, v54
v_perm_b32 v154, v53, v52, s84
v_mfma_f32_16x16x32_bf16 v[60:63], a[216:219], a[184:187], v[60:63]
v_exp_f32 v55, v55
v_mfma_f32_16x16x32_bf16 v[60:63], a[212:215], a[180:183], v[60:63]
v_perm_b32 v155, v55, v54, s84
v_exp_f32 v56, v56
v_mfma_f32_16x16x32_bf16 v[60:63], a[208:211], a[176:179], v[60:63]
s_waitcnt lgkmcnt(0)
v_exp_f32 v57, v57
v_mfma_f32_16x16x32_bf16 v[48:51], a[192:195], a[128:131], v[64:67]
ds_read_b128 a[208:211], v6 offset:17664
v_exp_f32 v58, v58
v_perm_b32 v170, v57, v56, s84
v_mfma_f32_16x16x32_bf16 v[48:51], a[196:199], a[132:135], v[48:51]
v_exp_f32 v59, v59
v_mfma_f32_16x16x32_bf16 v[48:51], a[200:203], a[136:139], v[48:51]
ds_read_b128 a[212:215], v6 offset:17728
v_perm_b32 v171, v59, v58, s84
v_exp_f32 v60, v60
v_mfma_f32_16x16x32_bf16 v[48:51], a[204:207], a[140:143], v[48:51]
s_waitcnt vmcnt(4)
buffer_load_dwordx4 v4, s[8:11], s20 offen offset:2112 nt lds
v_exp_f32 v61, v61
v_mfma_f32_16x16x32_bf16 v[52:55], a[204:207], a[156:159], v[68:71]
ds_read_b128 a[216:219], v6 offset:17792
v_exp_f32 v62, v62
v_perm_b32 v186, v61, v60, s84
v_mfma_f32_16x16x32_bf16 v[52:55], a[200:203], a[152:155], v[52:55]
v_exp_f32 v63, v63
v_mfma_f32_16x16x32_bf16 v[52:55], a[196:199], a[148:151], v[52:55]
ds_read_b128 a[220:223], v6 offset:17856
v_perm_b32 v187, v63, v62, s84
v_exp_f32 v48, v48
v_mfma_f32_16x16x32_bf16 v[52:55], a[192:195], a[144:147], v[52:55]
v_exp_f32 v49, v49
v_mfma_f32_16x16x32_bf16 v[56:59], a[192:195], a[160:163], v[72:75]
v_exp_f32 v50, v50
v_perm_b32 v140, v49, v48, s84
v_mfma_f32_16x16x32_bf16 v[56:59], a[196:199], a[164:167], v[56:59]
v_exp_f32 v51, v51
v_mfma_f32_16x16x32_bf16 v[56:59], a[200:203], a[168:171], v[56:59]
v_perm_b32 v141, v51, v50, s84
v_exp_f32 v52, v52
v_mfma_f32_16x16x32_bf16 v[56:59], a[204:207], a[172:175], v[56:59]
s_waitcnt vmcnt(4)
buffer_load_dwordx4 v5, s[8:11], s20 offen offset:3168 nt lds
v_exp_f32 v53, v53
v_mfma_f32_16x16x32_bf16 v[60:63], a[204:207], a[188:191], v[76:79]
s_sub_u32 s95, s95, s96
s_and_b32 s95, s95, s96
s_add_u32 s20, s95, s97
v_exp_f32 v54, v54
v_perm_b32 v156, v53, v52, s84
v_mfma_f32_16x16x32_bf16 v[60:63], a[200:203], a[184:187], v[60:63]
v_exp_f32 v55, v55
v_mfma_f32_16x16x32_bf16 v[60:63], a[196:199], a[180:183], v[60:63]
v_perm_b32 v157, v55, v54, s84
v_exp_f32 v56, v56
v_mfma_f32_16x16x32_bf16 v[60:63], a[192:195], a[176:179], v[60:63]
s_waitcnt vmcnt(4) lgkmcnt(0)
v_exp_f32 v57, v57
v_mfma_f32_16x16x32_bf16 v[48:51], a[208:211], a[128:131], v[64:67]
s_barrier
s_add_u32 m0, s22, 0
ds_read_b128 a[192:195], v6 offset:33792
v_exp_f32 v58, v58
v_perm_b32 v172, v57, v56, s84
v_mfma_f32_16x16x32_bf16 v[48:51], a[212:215], a[132:135], v[48:51]
s_waitcnt vmcnt(6)
buffer_load_dwordx4 v2, s[8:11], s20 offen offset:0 nt lds
v_exp_f32 v59, v59
v_mfma_f32_16x16x32_bf16 v[48:51], a[216:219], a[136:139], v[48:51]
ds_read_b128 a[196:199], v6 offset:33856
v_perm_b32 v173, v59, v58, s84
v_exp_f32 v60, v60
v_mfma_f32_16x16x32_bf16 v[48:51], a[220:223], a[140:143], v[48:51]
v_exp_f32 v61, v61
v_mfma_f32_16x16x32_bf16 v[52:55], a[220:223], a[156:159], v[68:71]
ds_read_b128 a[200:203], v6 offset:33920
v_exp_f32 v62, v62
v_perm_b32 v188, v61, v60, s84
v_mfma_f32_16x16x32_bf16 v[52:55], a[216:219], a[152:155], v[52:55]
s_waitcnt vmcnt(6)
buffer_load_dwordx4 v3, s[8:11], s20 offen offset:1056 nt lds
v_exp_f32 v63, v63
v_mfma_f32_16x16x32_bf16 v[52:55], a[212:215], a[148:151], v[52:55]
ds_read_b128 a[204:207], v6 offset:33984
v_perm_b32 v189, v63, v62, s84
v_exp_f32 v48, v48
v_mfma_f32_16x16x32_bf16 v[52:55], a[208:211], a[144:147], v[52:55]
v_exp_f32 v49, v49
v_mfma_f32_16x16x32_bf16 v[56:59], a[208:211], a[160:163], v[72:75]
ds_read_b64_tr_b16 a[224:225], v7 offset:0
v_exp_f32 v50, v50
v_perm_b32 v142, v49, v48, s84
v_mfma_f32_16x16x32_bf16 v[56:59], a[212:215], a[164:167], v[56:59]
ds_read_b64_tr_b16 a[226:227], v7 offset:256
s_waitcnt vmcnt(6)
buffer_load_dwordx4 v4, s[8:11], s20 offen offset:2112 nt lds
v_exp_f32 v51, v51
v_mfma_f32_16x16x32_bf16 v[56:59], a[216:219], a[168:171], v[56:59]
ds_read_b64_tr_b16 a[228:229], v7 offset:512
v_perm_b32 v143, v51, v50, s84
v_exp_f32 v52, v52
v_mfma_f32_16x16x32_bf16 v[56:59], a[220:223], a[172:175], v[56:59]
ds_read_b64_tr_b16 a[230:231], v7 offset:768
v_exp_f32 v53, v53
v_mfma_f32_16x16x32_bf16 v[60:63], a[220:223], a[188:191], v[76:79]
ds_read_b64_tr_b16 a[232:233], v7 offset:16896
v_exp_f32 v54, v54
v_perm_b32 v158, v53, v52, s84
v_mfma_f32_16x16x32_bf16 v[60:63], a[216:219], a[184:187], v[60:63]
ds_read_b64_tr_b16 a[234:235], v7 offset:17152
s_waitcnt vmcnt(6)
buffer_load_dwordx4 v5, s[8:11], s20 offen offset:3168 nt lds
v_exp_f32 v55, v55
v_mfma_f32_16x16x32_bf16 v[60:63], a[212:215], a[180:183], v[60:63]
s_xor_b32 s20, s20, 8192
ds_read_b64_tr_b16 a[236:237], v7 offset:17408
v_perm_b32 v159, v55, v54, s84
v_exp_f32 v56, v56
v_mfma_f32_16x16x32_bf16 v[60:63], a[208:211], a[176:179], v[60:63]
ds_read_b64_tr_b16 a[238:239], v7 offset:17664
v_exp_f32 v57, v57
s_nop 0
v_perm_b32 v174, v57, v56, s84
v_exp_f32 v58, v58
v_exp_f32 v59, v59
s_nop 0
v_perm_b32 v175, v59, v58, s84
v_exp_f32 v60, v60
s_waitcnt lgkmcnt(0)
.p2align 6
L_loop:
v_mfma_f32_16x16x32_bf16 v[48:51], a[192:195], a[128:131], v[64:67]
ds_read_b128 a[208:211], v6 offset:34048
v_mfma_f32_16x16x32_bf16 v[48:51], a[196:199], a[132:135], v[48:51]
v_exp_f32 v61, v61
v_mfma_f32_16x16x32_bf16 v[48:51], a[200:203], a[136:139], v[48:51]
ds_read_b128 a[212:215], v6 offset:34112
v_perm_b32 v190, v61, v60, s84
v_mfma_f32_16x16x32_bf16 v[48:51], a[204:207], a[140:143], v[48:51]
v_exp_f32 v62, v62
v_mfma_f32_16x16x32_bf16 v[52:55], a[204:207], a[156:159], v[68:71]
ds_read_b128 a[216:219], v6 offset:34176
v_mfma_f32_16x16x32_bf16 v[52:55], a[200:203], a[152:155], v[52:55]
v_exp_f32 v63, v63
v_mfma_f32_16x16x32_bf16 v[52:55], a[196:199], a[148:151], v[52:55]
ds_read_b128 a[220:223], v6 offset:34240
v_perm_b32 v191, v63, v62, s84
v_mfma_f32_16x16x32_bf16 v[52:55], a[192:195], a[144:147], v[52:55]
v_exp_f32 v48, v48
v_mfma_f32_16x16x32_bf16 v[56:59], a[192:195], a[160:163], v[72:75]
ds_read_b64_tr_b16 a[240:241], v7 offset:32
v_mfma_f32_16x16x32_bf16 v[56:59], a[196:199], a[164:167], v[56:59]
v_exp_f32 v49, v49
v_mfma_f32_16x16x32_bf16 v[56:59], a[200:203], a[168:171], v[56:59]
ds_read_b64_tr_b16 a[242:243], v7 offset:288
v_perm_b32 v192, v49, v48, s84
v_mfma_f32_16x16x32_bf16 v[56:59], a[204:207], a[172:175], v[56:59]
v_exp_f32 v50, v50
v_mfma_f32_16x16x32_bf16 v[60:63], a[204:207], a[188:191], v[76:79]
ds_read_b64_tr_b16 a[244:245], v7 offset:544
v_mfma_f32_16x16x32_bf16 v[60:63], a[200:203], a[184:187], v[60:63]
v_exp_f32 v51, v51
v_mfma_f32_16x16x32_bf16 v[60:63], a[196:199], a[180:183], v[60:63]
ds_read_b64_tr_b16 a[246:247], v7 offset:800
v_perm_b32 v193, v51, v50, s84
v_mfma_f32_16x16x32_bf16 v[60:63], a[192:195], a[176:179], v[60:63]
v_exp_f32 v52, v52
v_mfma_f32_16x16x32_bf16 a[0:3], v[128:131], a[224:227], a[0:3]
ds_read_b64_tr_b16 a[248:249], v7 offset:16928
v_mfma_f32_16x16x32_bf16 a[0:3], v[132:135], a[228:231], a[0:3]
v_exp_f32 v53, v53
v_mfma_f32_16x16x32_bf16 a[0:3], v[136:139], a[232:235], a[0:3]
ds_read_b64_tr_b16 a[250:251], v7 offset:17184
v_perm_b32 v208, v53, v52, s84
v_mfma_f32_16x16x32_bf16 a[0:3], v[140:143], a[236:239], a[0:3]
v_exp_f32 v54, v54
v_mfma_f32_16x16x32_bf16 a[32:35], v[156:159], a[236:239], a[32:35]
ds_read_b64_tr_b16 a[252:253], v7 offset:17440
v_mfma_f32_16x16x32_bf16 a[32:35], v[152:155], a[232:235], a[32:35]
v_exp_f32 v55, v55
v_mfma_f32_16x16x32_bf16 a[32:35], v[148:151], a[228:231], a[32:35]
ds_read_b64_tr_b16 a[254:255], v7 offset:17696
v_perm_b32 v209, v55, v54, s84
v_mfma_f32_16x16x32_bf16 a[32:35], v[144:147], a[224:227], a[32:35]
s_add_u32 m0, s22, 101376
v_exp_f32 v56, v56
v_mfma_f32_16x16x32_bf16 a[64:67], v[160:163], a[224:227], a[64:67]
buffer_load_dwordx4 v2, s[12:15], s21 offen offset:0 nt lds
v_mfma_f32_16x16x32_bf16 a[64:67], v[164:167], a[228:231], a[64:67]
v_exp_f32 v57, v57
v_mfma_f32_16x16x32_bf16 a[64:67], v[168:171], a[232:235], a[64:67]
v_perm_b32 v224, v57, v56, s84
v_mfma_f32_16x16x32_bf16 a[64:67], v[172:175], a[236:239], a[64:67]
v_exp_f32 v58, v58
v_mfma_f32_16x16x32_bf16 a[96:99], v[188:191], a[236:239], a[96:99]
buffer_load_dwordx4 v3, s[12:15], s21 offen offset:1056 nt lds
v_mfma_f32_16x16x32_bf16 a[96:99], v[184:187], a[232:235], a[96:99]
v_exp_f32 v59, v59
v_mfma_f32_16x16x32_bf16 a[96:99], v[180:183], a[228:231], a[96:99]
s_waitcnt vmcnt(4)
v_perm_b32 v225, v59, v58, s84
v_mfma_f32_16x16x32_bf16 a[96:99], v[176:179], a[224:227], a[96:99]
s_waitcnt lgkmcnt(0)
v_exp_f32 v60, v60
v_mfma_f32_16x16x32_bf16 v[48:51], a[208:211], a[128:131], v[64:67]
ds_read_b128 a[192:195], v6 offset:34304
v_mfma_f32_16x16x32_bf16 v[48:51], a[212:215], a[132:135], v[48:51]
v_exp_f32 v61, v61
v_mfma_f32_16x16x32_bf16 v[48:51], a[216:219], a[136:139], v[48:51]
ds_read_b128 a[196:199], v6 offset:34368
v_perm_b32 v240, v61, v60, s84
v_mfma_f32_16x16x32_bf16 v[48:51], a[220:223], a[140:143], v[48:51]
v_exp_f32 v62, v62
v_mfma_f32_16x16x32_bf16 v[52:55], a[220:223], a[156:159], v[68:71]
ds_read_b128 a[200:203], v6 offset:34432
v_mfma_f32_16x16x32_bf16 v[52:55], a[216:219], a[152:155], v[52:55]
v_exp_f32 v63, v63
v_mfma_f32_16x16x32_bf16 v[52:55], a[212:215], a[148:151], v[52:55]
ds_read_b128 a[204:207], v6 offset:34496
v_perm_b32 v241, v63, v62, s84
v_mfma_f32_16x16x32_bf16 v[52:55], a[208:211], a[144:147], v[52:55]
v_exp_f32 v48, v48
v_mfma_f32_16x16x32_bf16 v[56:59], a[208:211], a[160:163], v[72:75]
ds_read_b64_tr_b16 a[224:225], v7 offset:64
v_mfma_f32_16x16x32_bf16 v[56:59], a[212:215], a[164:167], v[56:59]
v_exp_f32 v49, v49
v_mfma_f32_16x16x32_bf16 v[56:59], a[216:219], a[168:171], v[56:59]
ds_read_b64_tr_b16 a[226:227], v7 offset:320
v_perm_b32 v194, v49, v48, s84
v_mfma_f32_16x16x32_bf16 v[56:59], a[220:223], a[172:175], v[56:59]
v_exp_f32 v50, v50
v_mfma_f32_16x16x32_bf16 v[60:63], a[220:223], a[188:191], v[76:79]
ds_read_b64_tr_b16 a[228:229], v7 offset:576
v_mfma_f32_16x16x32_bf16 v[60:63], a[216:219], a[184:187], v[60:63]
v_exp_f32 v51, v51
v_mfma_f32_16x16x32_bf16 v[60:63], a[212:215], a[180:183], v[60:63]
ds_read_b64_tr_b16 a[230:231], v7 offset:832
v_perm_b32 v195, v51, v50, s84
v_mfma_f32_16x16x32_bf16 v[60:63], a[208:211], a[176:179], v[60:63]
v_exp_f32 v52, v52
v_smfmac_f32_16x16x64_bf16 v[84:87], v[80:83], v[128:135], v45
v_smfmac_f32_16x16x64_bf16 v[84:87], v[80:83], v[136:143], v45
v_mfma_f32_16x16x32_bf16 a[4:7], v[128:131], a[240:243], a[4:7]
ds_read_b64_tr_b16 a[232:233], v7 offset:16960
v_mfma_f32_16x16x32_bf16 a[4:7], v[132:135], a[244:247], a[4:7]
v_exp_f32 v53, v53
v_mfma_f32_16x16x32_bf16 a[4:7], v[136:139], a[248:251], a[4:7]
ds_read_b64_tr_b16 a[234:235], v7 offset:17216
v_perm_b32 v210, v53, v52, s84
v_mfma_f32_16x16x32_bf16 a[4:7], v[140:143], a[252:255], a[4:7]
v_exp_f32 v54, v54
v_mfma_f32_16x16x32_bf16 a[36:39], v[156:159], a[252:255], a[36:39]
ds_read_b64_tr_b16 a[236:237], v7 offset:17472
v_mfma_f32_16x16x32_bf16 a[36:39], v[152:155], a[248:251], a[36:39]
v_exp_f32 v55, v55
v_mfma_f32_16x16x32_bf16 a[36:39], v[148:151], a[244:247], a[36:39]
ds_read_b64_tr_b16 a[238:239], v7 offset:17728
v_perm_b32 v211, v55, v54, s84
v_mfma_f32_16x16x32_bf16 a[36:39], v[144:147], a[240:243], a[36:39]
v_exp_f32 v56, v56
v_mfma_f32_16x16x32_bf16 a[68:71], v[160:163], a[240:243], a[68:71]
buffer_load_dwordx4 v4, s[12:15], s21 offen offset:2112 nt lds
v_mfma_f32_16x16x32_bf16 a[68:71], v[164:167], a[244:247], a[68:71]
v_exp_f32 v57, v57
v_mfma_f32_16x16x32_bf16 a[68:71], v[168:171], a[248:251], a[68:71]
v_perm_b32 v226, v57, v56, s84
v_mfma_f32_16x16x32_bf16 a[68:71], v[172:175], a[252:255], a[68:71]
v_exp_f32 v58, v58
v_mfma_f32_16x16x32_bf16 a[100:103], v[188:191], a[252:255], a[100:103]
buffer_load_dwordx4 v5, s[12:15], s21 offen offset:3168 nt lds
v_mfma_f32_16x16x32_bf16 a[100:103], v[184:187], a[248:251], a[100:103]
s_xor_b32 s21, s21, 8192
v_exp_f32 v59, v59
v_mfma_f32_16x16x32_bf16 a[100:103], v[180:183], a[244:247], a[100:103]
s_waitcnt vmcnt(4)
v_perm_b32 v227, v59, v58, s84
v_mfma_f32_16x16x32_bf16 a[100:103], v[176:179], a[240:243], a[100:103]
s_waitcnt lgkmcnt(0)
v_exp_f32 v60, v60
v_mfma_f32_16x16x32_bf16 v[48:51], a[192:195], a[128:131], v[64:67]
ds_read_b128 a[208:211], v6 offset:34560
v_mfma_f32_16x16x32_bf16 v[48:51], a[196:199], a[132:135], v[48:51]
v_exp_f32 v61, v61
v_mfma_f32_16x16x32_bf16 v[48:51], a[200:203], a[136:139], v[48:51]
ds_read_b128 a[212:215], v6 offset:34624
v_perm_b32 v242, v61, v60, s84
v_mfma_f32_16x16x32_bf16 v[48:51], a[204:207], a[140:143], v[48:51]
v_exp_f32 v62, v62
v_mfma_f32_16x16x32_bf16 v[52:55], a[204:207], a[156:159], v[68:71]
ds_read_b128 a[216:219], v6 offset:34688
v_mfma_f32_16x16x32_bf16 v[52:55], a[200:203], a[152:155], v[52:55]
v_exp_f32 v63, v63
v_mfma_f32_16x16x32_bf16 v[52:55], a[196:199], a[148:151], v[52:55]
ds_read_b128 a[220:223], v6 offset:34752
v_perm_b32 v243, v63, v62, s84
v_mfma_f32_16x16x32_bf16 v[52:55], a[192:195], a[144:147], v[52:55]
v_exp_f32 v48, v48
v_mfma_f32_16x16x32_bf16 v[56:59], a[192:195], a[160:163], v[72:75]
ds_read_b64_tr_b16 a[240:241], v7 offset:96
v_mfma_f32_16x16x32_bf16 v[56:59], a[196:199], a[164:167], v[56:59]
v_exp_f32 v49, v49
v_mfma_f32_16x16x32_bf16 v[56:59], a[200:203], a[168:171], v[56:59]
ds_read_b64_tr_b16 a[242:243], v7 offset:352
v_perm_b32 v196, v49, v48, s84
v_mfma_f32_16x16x32_bf16 v[56:59], a[204:207], a[172:175], v[56:59]
v_exp_f32 v50, v50
v_mfma_f32_16x16x32_bf16 v[60:63], a[204:207], a[188:191], v[76:79]
ds_read_b64_tr_b16 a[244:245], v7 offset:608
v_mfma_f32_16x16x32_bf16 v[60:63], a[200:203], a[184:187], v[60:63]
v_exp_f32 v51, v51
v_mfma_f32_16x16x32_bf16 v[60:63], a[196:199], a[180:183], v[60:63]
ds_read_b64_tr_b16 a[246:247], v7 offset:864
v_perm_b32 v197, v51, v50, s84
v_mfma_f32_16x16x32_bf16 v[60:63], a[192:195], a[176:179], v[60:63]
v_exp_f32 v52, v52
v_mfma_f32_16x16x32_bf16 a[8:11], v[128:131], a[224:227], a[8:11]
ds_read_b64_tr_b16 a[248:249], v7 offset:16992
v_mfma_f32_16x16x32_bf16 a[8:11], v[132:135], a[228:231], a[8:11]
v_exp_f32 v53, v53
v_mfma_f32_16x16x32_bf16 a[8:11], v[136:139], a[232:235], a[8:11]
ds_read_b64_tr_b16 a[250:251], v7 offset:17248
v_perm_b32 v212, v53, v52, s84
v_mfma_f32_16x16x32_bf16 a[8:11], v[140:143], a[236:239], a[8:11]
v_exp_f32 v54, v54
v_mfma_f32_16x16x32_bf16 a[40:43], v[156:159], a[236:239], a[40:43]
ds_read_b64_tr_b16 a[252:253], v7 offset:17504
v_mfma_f32_16x16x32_bf16 a[40:43], v[152:155], a[232:235], a[40:43]
v_exp_f32 v55, v55
v_mfma_f32_16x16x32_bf16 a[40:43], v[148:151], a[228:231], a[40:43]
ds_read_b64_tr_b16 a[254:255], v7 offset:17760
v_perm_b32 v213, v55, v54, s84
v_mfma_f32_16x16x32_bf16 a[40:43], v[144:147], a[224:227], a[40:43]
s_add_u32 m0, s22, 118272
v_exp_f32 v56, v56
v_mfma_f32_16x16x32_bf16 a[72:75], v[160:163], a[224:227], a[72:75]
buffer_load_dwordx4 v2, s[12:15], s21 offen offset:0 nt lds
v_mfma_f32_16x16x32_bf16 a[72:75], v[164:167], a[228:231], a[72:75]
v_exp_f32 v57, v57
v_mfma_f32_16x16x32_bf16 a[72:75], v[168:171], a[232:235], a[72:75]
v_perm_b32 v228, v57, v56, s84
v_mfma_f32_16x16x32_bf16 a[72:75], v[172:175], a[236:239], a[72:75]
v_exp_f32 v58, v58
v_mfma_f32_16x16x32_bf16 a[104:107], v[188:191], a[236:239], a[104:107]
buffer_load_dwordx4 v3, s[12:15], s21 offen offset:1056 nt lds
v_mfma_f32_16x16x32_bf16 a[104:107], v[184:187], a[232:235], a[104:107]
v_exp_f32 v59, v59
v_mfma_f32_16x16x32_bf16 a[104:107], v[180:183], a[228:231], a[104:107]
s_waitcnt vmcnt(4)
v_perm_b32 v229, v59, v58, s84
v_mfma_f32_16x16x32_bf16 a[104:107], v[176:179], a[224:227], a[104:107]
s_waitcnt vmcnt(10) lgkmcnt(0)
v_exp_f32 v60, v60
v_mfma_f32_16x16x32_bf16 v[48:51], a[208:211], a[128:131], v[64:67]
s_barrier
ds_read_b128 a[192:195], v6 offset:50688
v_mfma_f32_16x16x32_bf16 v[48:51], a[212:215], a[132:135], v[48:51]
v_exp_f32 v61, v61
v_mfma_f32_16x16x32_bf16 v[48:51], a[216:219], a[136:139], v[48:51]
ds_read_b128 a[196:199], v6 offset:50752
v_perm_b32 v244, v61, v60, s84
v_mfma_f32_16x16x32_bf16 v[48:51], a[220:223], a[140:143], v[48:51]
v_exp_f32 v62, v62
v_mfma_f32_16x16x32_bf16 v[52:55], a[220:223], a[156:159], v[68:71]
ds_read_b128 a[200:203], v6 offset:50816
v_mfma_f32_16x16x32_bf16 v[52:55], a[216:219], a[152:155], v[52:55]
v_exp_f32 v63, v63
v_mfma_f32_16x16x32_bf16 v[52:55], a[212:215], a[148:151], v[52:55]
ds_read_b128 a[204:207], v6 offset:50880
v_perm_b32 v245, v63, v62, s84
v_mfma_f32_16x16x32_bf16 v[52:55], a[208:211], a[144:147], v[52:55]
v_exp_f32 v48, v48
v_mfma_f32_16x16x32_bf16 v[56:59], a[208:211], a[160:163], v[72:75]
ds_read_b64_tr_b16 a[224:225], v7 offset:128
v_mfma_f32_16x16x32_bf16 v[56:59], a[212:215], a[164:167], v[56:59]
v_exp_f32 v49, v49
v_mfma_f32_16x16x32_bf16 v[56:59], a[216:219], a[168:171], v[56:59]
ds_read_b64_tr_b16 a[226:227], v7 offset:384
v_perm_b32 v198, v49, v48, s84
v_mfma_f32_16x16x32_bf16 v[56:59], a[220:223], a[172:175], v[56:59]
v_exp_f32 v50, v50
v_mfma_f32_16x16x32_bf16 v[60:63], a[220:223], a[188:191], v[76:79]
ds_read_b64_tr_b16 a[228:229], v7 offset:640
v_mfma_f32_16x16x32_bf16 v[60:63], a[216:219], a[184:187], v[60:63]
v_exp_f32 v51, v51
v_mfma_f32_16x16x32_bf16 v[60:63], a[212:215], a[180:183], v[60:63]
ds_read_b64_tr_b16 a[230:231], v7 offset:896
v_perm_b32 v199, v51, v50, s84
v_mfma_f32_16x16x32_bf16 v[60:63], a[208:211], a[176:179], v[60:63]
v_exp_f32 v52, v52
v_smfmac_f32_16x16x64_bf16 v[88:91], v[80:83], v[144:151], v45
v_smfmac_f32_16x16x64_bf16 v[88:91], v[80:83], v[152:159], v45
v_mfma_f32_16x16x32_bf16 a[12:15], v[128:131], a[240:243], a[12:15]
ds_read_b64_tr_b16 a[232:233], v7 offset:17024
v_mfma_f32_16x16x32_bf16 a[12:15], v[132:135], a[244:247], a[12:15]
v_exp_f32 v53, v53
v_mfma_f32_16x16x32_bf16 a[12:15], v[136:139], a[248:251], a[12:15]
ds_read_b64_tr_b16 a[234:235], v7 offset:17280
v_perm_b32 v214, v53, v52, s84
v_mfma_f32_16x16x32_bf16 a[12:15], v[140:143], a[252:255], a[12:15]
v_exp_f32 v54, v54
v_mfma_f32_16x16x32_bf16 a[44:47], v[156:159], a[252:255], a[44:47]
ds_read_b64_tr_b16 a[236:237], v7 offset:17536
v_mfma_f32_16x16x32_bf16 a[44:47], v[152:155], a[248:251], a[44:47]
v_exp_f32 v55, v55
v_mfma_f32_16x16x32_bf16 a[44:47], v[148:151], a[244:247], a[44:47]
ds_read_b64_tr_b16 a[238:239], v7 offset:17792
v_perm_b32 v215, v55, v54, s84
v_mfma_f32_16x16x32_bf16 a[44:47], v[144:147], a[240:243], a[44:47]
v_exp_f32 v56, v56
v_mfma_f32_16x16x32_bf16 a[76:79], v[160:163], a[240:243], a[76:79]
buffer_load_dwordx4 v4, s[12:15], s21 offen offset:2112 nt lds
v_mfma_f32_16x16x32_bf16 a[76:79], v[164:167], a[244:247], a[76:79]
v_exp_f32 v57, v57
v_mfma_f32_16x16x32_bf16 a[76:79], v[168:171], a[248:251], a[76:79]
v_perm_b32 v230, v57, v56, s84
v_mfma_f32_16x16x32_bf16 a[76:79], v[172:175], a[252:255], a[76:79]
v_exp_f32 v58, v58
v_mfma_f32_16x16x32_bf16 a[108:111], v[188:191], a[252:255], a[108:111]
buffer_load_dwordx4 v5, s[12:15], s21 offen offset:3168 nt lds
v_mfma_f32_16x16x32_bf16 a[108:111], v[184:187], a[248:251], a[108:111]
s_sub_u32 s94, s94, s96
s_and_b32 s94, s94, s96
s_add_u32 s21, s94, s97
v_exp_f32 v59, v59
v_mfma_f32_16x16x32_bf16 a[108:111], v[180:183], a[244:247], a[108:111]
s_waitcnt vmcnt(4)
v_perm_b32 v231, v59, v58, s84
v_mfma_f32_16x16x32_bf16 a[108:111], v[176:179], a[240:243], a[108:111]
s_waitcnt lgkmcnt(0)
v_exp_f32 v60, v60
v_mfma_f32_16x16x32_bf16 v[48:51], a[192:195], a[128:131], v[64:67]
ds_read_b128 a[208:211], v6 offset:50944
v_mfma_f32_16x16x32_bf16 v[48:51], a[196:199], a[132:135], v[48:51]
v_exp_f32 v61, v61
v_mfma_f32_16x16x32_bf16 v[48:51], a[200:203], a[136:139], v[48:51]
ds_read_b128 a[212:215], v6 offset:51008
v_perm_b32 v246, v61, v60, s84
v_mfma_f32_16x16x32_bf16 v[48:51], a[204:207], a[140:143], v[48:51]
v_exp_f32 v62, v62
v_mfma_f32_16x16x32_bf16 v[52:55], a[204:207], a[156:159], v[68:71]
ds_read_b128 a[216:219], v6 offset:51072
v_mfma_f32_16x16x32_bf16 v[52:55], a[200:203], a[152:155], v[52:55]
v_exp_f32 v63, v63
v_mfma_f32_16x16x32_bf16 v[52:55], a[196:199], a[148:151], v[52:55]
ds_read_b128 a[220:223], v6 offset:51136
v_perm_b32 v247, v63, v62, s84
v_mfma_f32_16x16x32_bf16 v[52:55], a[192:195], a[144:147], v[52:55]
v_exp_f32 v48, v48
v_mfma_f32_16x16x32_bf16 v[56:59], a[192:195], a[160:163], v[72:75]
ds_read_b64_tr_b16 a[240:241], v7 offset:160
v_mfma_f32_16x16x32_bf16 v[56:59], a[196:199], a[164:167], v[56:59]
v_exp_f32 v49, v49
v_mfma_f32_16x16x32_bf16 v[56:59], a[200:203], a[168:171], v[56:59]
ds_read_b64_tr_b16 a[242:243], v7 offset:416
v_perm_b32 v200, v49, v48, s84
v_mfma_f32_16x16x32_bf16 v[56:59], a[204:207], a[172:175], v[56:59]
v_exp_f32 v50, v50
v_mfma_f32_16x16x32_bf16 v[60:63], a[204:207], a[188:191], v[76:79]
ds_read_b64_tr_b16 a[244:245], v7 offset:672
v_mfma_f32_16x16x32_bf16 v[60:63], a[200:203], a[184:187], v[60:63]
v_exp_f32 v51, v51
v_mfma_f32_16x16x32_bf16 v[60:63], a[196:199], a[180:183], v[60:63]
ds_read_b64_tr_b16 a[246:247], v7 offset:928
v_perm_b32 v201, v51, v50, s84
v_mfma_f32_16x16x32_bf16 v[60:63], a[192:195], a[176:179], v[60:63]
v_exp_f32 v52, v52
v_mfma_f32_16x16x32_bf16 a[16:19], v[128:131], a[224:227], a[16:19]
ds_read_b64_tr_b16 a[248:249], v7 offset:17056
v_mfma_f32_16x16x32_bf16 a[16:19], v[132:135], a[228:231], a[16:19]
v_exp_f32 v53, v53
v_mfma_f32_16x16x32_bf16 a[16:19], v[136:139], a[232:235], a[16:19]
ds_read_b64_tr_b16 a[250:251], v7 offset:17312
v_perm_b32 v216, v53, v52, s84
v_mfma_f32_16x16x32_bf16 a[16:19], v[140:143], a[236:239], a[16:19]
v_exp_f32 v54, v54
v_mfma_f32_16x16x32_bf16 a[48:51], v[156:159], a[236:239], a[48:51]
ds_read_b64_tr_b16 a[252:253], v7 offset:17568
v_mfma_f32_16x16x32_bf16 a[48:51], v[152:155], a[232:235], a[48:51]
v_exp_f32 v55, v55
v_mfma_f32_16x16x32_bf16 a[48:51], v[148:151], a[228:231], a[48:51]
ds_read_b64_tr_b16 a[254:255], v7 offset:17824
v_perm_b32 v217, v55, v54, s84
v_mfma_f32_16x16x32_bf16 a[48:51], v[144:147], a[224:227], a[48:51]
s_add_u32 m0, s22, 16896
v_exp_f32 v56, v56
v_mfma_f32_16x16x32_bf16 a[80:83], v[160:163], a[224:227], a[80:83]
buffer_load_dwordx4 v2, s[8:11], s20 offen offset:0 nt lds
v_mfma_f32_16x16x32_bf16 a[80:83], v[164:167], a[228:231], a[80:83]
v_exp_f32 v57, v57
v_mfma_f32_16x16x32_bf16 a[80:83], v[168:171], a[232:235], a[80:83]
v_perm_b32 v232, v57, v56, s84
v_mfma_f32_16x16x32_bf16 a[80:83], v[172:175], a[236:239], a[80:83]
v_exp_f32 v58, v58
v_mfma_f32_16x16x32_bf16 a[112:115], v[188:191], a[236:239], a[112:115]
buffer_load_dwordx4 v3, s[8:11], s20 offen offset:1056 nt lds
v_mfma_f32_16x16x32_bf16 a[112:115], v[184:187], a[232:235], a[112:115]
v_exp_f32 v59, v59
v_mfma_f32_16x16x32_bf16 a[112:115], v[180:183], a[228:231], a[112:115]
s_waitcnt vmcnt(4)
v_perm_b32 v233, v59, v58, s84
v_mfma_f32_16x16x32_bf16 a[112:115], v[176:179], a[224:227], a[112:115]
s_waitcnt lgkmcnt(0)
v_exp_f32 v60, v60
v_mfma_f32_16x16x32_bf16 v[48:51], a[208:211], a[128:131], v[64:67]
ds_read_b128 a[192:195], v6 offset:51200
v_mfma_f32_16x16x32_bf16 v[48:51], a[212:215], a[132:135], v[48:51]
v_exp_f32 v61, v61
v_mfma_f32_16x16x32_bf16 v[48:51], a[216:219], a[136:139], v[48:51]
ds_read_b128 a[196:199], v6 offset:51264
v_perm_b32 v248, v61, v60, s84
v_mfma_f32_16x16x32_bf16 v[48:51], a[220:223], a[140:143], v[48:51]
v_exp_f32 v62, v62
v_mfma_f32_16x16x32_bf16 v[52:55], a[220:223], a[156:159], v[68:71]
ds_read_b128 a[200:203], v6 offset:51328
v_mfma_f32_16x16x32_bf16 v[52:55], a[216:219], a[152:155], v[52:55]
v_exp_f32 v63, v63
v_mfma_f32_16x16x32_bf16 v[52:55], a[212:215], a[148:151], v[52:55]
ds_read_b128 a[204:207], v6 offset:51392
v_perm_b32 v249, v63, v62, s84
v_mfma_f32_16x16x32_bf16 v[52:55], a[208:211], a[144:147], v[52:55]
v_exp_f32 v48, v48
v_mfma_f32_16x16x32_bf16 v[56:59], a[208:211], a[160:163], v[72:75]
ds_read_b64_tr_b16 a[224:225], v7 offset:192
v_mfma_f32_16x16x32_bf16 v[56:59], a[212:215], a[164:167], v[56:59]
v_exp_f32 v49, v49
v_mfma_f32_16x16x32_bf16 v[56:59], a[216:219], a[168:171], v[56:59]
ds_read_b64_tr_b16 a[226:227], v7 offset:448
v_perm_b32 v202, v49, v48, s84
v_mfma_f32_16x16x32_bf16 v[56:59], a[220:223], a[172:175], v[56:59]
v_exp_f32 v50, v50
v_mfma_f32_16x16x32_bf16 v[60:63], a[220:223], a[188:191], v[76:79]
ds_read_b64_tr_b16 a[228:229], v7 offset:704
v_mfma_f32_16x16x32_bf16 v[60:63], a[216:219], a[184:187], v[60:63]
v_exp_f32 v51, v51
v_mfma_f32_16x16x32_bf16 v[60:63], a[212:215], a[180:183], v[60:63]
ds_read_b64_tr_b16 a[230:231], v7 offset:960
v_perm_b32 v203, v51, v50, s84
v_mfma_f32_16x16x32_bf16 v[60:63], a[208:211], a[176:179], v[60:63]
v_exp_f32 v52, v52
v_smfmac_f32_16x16x64_bf16 v[92:95], v[80:83], v[160:167], v45
v_smfmac_f32_16x16x64_bf16 v[92:95], v[80:83], v[168:175], v45
v_mfma_f32_16x16x32_bf16 a[20:23], v[128:131], a[240:243], a[20:23]
ds_read_b64_tr_b16 a[232:233], v7 offset:17088
v_mfma_f32_16x16x32_bf16 a[20:23], v[132:135], a[244:247], a[20:23]
v_exp_f32 v53, v53
v_mfma_f32_16x16x32_bf16 a[20:23], v[136:139], a[248:251], a[20:23]
ds_read_b64_tr_b16 a[234:235], v7 offset:17344
v_perm_b32 v218, v53, v52, s84
v_mfma_f32_16x16x32_bf16 a[20:23], v[140:143], a[252:255], a[20:23]
v_exp_f32 v54, v54
v_mfma_f32_16x16x32_bf16 a[52:55], v[156:159], a[252:255], a[52:55]
ds_read_b64_tr_b16 a[236:237], v7 offset:17600
v_mfma_f32_16x16x32_bf16 a[52:55], v[152:155], a[248:251], a[52:55]
v_exp_f32 v55, v55
v_mfma_f32_16x16x32_bf16 a[52:55], v[148:151], a[244:247], a[52:55]
ds_read_b64_tr_b16 a[238:239], v7 offset:17856
v_perm_b32 v219, v55, v54, s84
v_mfma_f32_16x16x32_bf16 a[52:55], v[144:147], a[240:243], a[52:55]
v_exp_f32 v56, v56
v_mfma_f32_16x16x32_bf16 a[84:87], v[160:163], a[240:243], a[84:87]
buffer_load_dwordx4 v4, s[8:11], s20 offen offset:2112 nt lds
v_mfma_f32_16x16x32_bf16 a[84:87], v[164:167], a[244:247], a[84:87]
v_exp_f32 v57, v57
v_mfma_f32_16x16x32_bf16 a[84:87], v[168:171], a[248:251], a[84:87]
v_perm_b32 v234, v57, v56, s84
v_mfma_f32_16x16x32_bf16 a[84:87], v[172:175], a[252:255], a[84:87]
v_exp_f32 v58, v58
v_mfma_f32_16x16x32_bf16 a[116:119], v[188:191], a[252:255], a[116:119]
buffer_load_dwordx4 v5, s[8:11], s20 offen offset:3168 nt lds
v_mfma_f32_16x16x32_bf16 a[116:119], v[184:187], a[248:251], a[116:119]
s_xor_b32 s20, s20, 24576
v_exp_f32 v59, v59
v_mfma_f32_16x16x32_bf16 a[116:119], v[180:183], a[244:247], a[116:119]
s_waitcnt vmcnt(4)
v_perm_b32 v235, v59, v58, s84
v_mfma_f32_16x16x32_bf16 a[116:119], v[176:179], a[240:243], a[116:119]
s_waitcnt lgkmcnt(0)
v_exp_f32 v60, v60
v_mfma_f32_16x16x32_bf16 v[48:51], a[192:195], a[128:131], v[64:67]
ds_read_b128 a[208:211], v6 offset:51456
v_mfma_f32_16x16x32_bf16 v[48:51], a[196:199], a[132:135], v[48:51]
v_exp_f32 v61, v61
v_mfma_f32_16x16x32_bf16 v[48:51], a[200:203], a[136:139], v[48:51]
ds_read_b128 a[212:215], v6 offset:51520
v_perm_b32 v250, v61, v60, s84
v_mfma_f32_16x16x32_bf16 v[48:51], a[204:207], a[140:143], v[48:51]
v_exp_f32 v62, v62
v_mfma_f32_16x16x32_bf16 v[52:55], a[204:207], a[156:159], v[68:71]
ds_read_b128 a[216:219], v6 offset:51584
v_mfma_f32_16x16x32_bf16 v[52:55], a[200:203], a[152:155], v[52:55]
v_exp_f32 v63, v63
v_mfma_f32_16x16x32_bf16 v[52:55], a[196:199], a[148:151], v[52:55]
ds_read_b128 a[220:223], v6 offset:51648
v_perm_b32 v251, v63, v62, s84
v_mfma_f32_16x16x32_bf16 v[52:55], a[192:195], a[144:147], v[52:55]
v_exp_f32 v48, v48
v_mfma_f32_16x16x32_bf16 v[56:59], a[192:195], a[160:163], v[72:75]
ds_read_b64_tr_b16 a[240:241], v7 offset:224
v_mfma_f32_16x16x32_bf16 v[56:59], a[196:199], a[164:167], v[56:59]
v_exp_f32 v49, v49
v_mfma_f32_16x16x32_bf16 v[56:59], a[200:203], a[168:171], v[56:59]
ds_read_b64_tr_b16 a[242:243], v7 offset:480
v_perm_b32 v204, v49, v48, s84
v_mfma_f32_16x16x32_bf16 v[56:59], a[204:207], a[172:175], v[56:59]
v_exp_f32 v50, v50
v_mfma_f32_16x16x32_bf16 v[60:63], a[204:207], a[188:191], v[76:79]
ds_read_b64_tr_b16 a[244:245], v7 offset:736
v_mfma_f32_16x16x32_bf16 v[60:63], a[200:203], a[184:187], v[60:63]
v_exp_f32 v51, v51
v_mfma_f32_16x16x32_bf16 v[60:63], a[196:199], a[180:183], v[60:63]
ds_read_b64_tr_b16 a[246:247], v7 offset:992
v_perm_b32 v205, v51, v50, s84
v_mfma_f32_16x16x32_bf16 v[60:63], a[192:195], a[176:179], v[60:63]
v_exp_f32 v52, v52
v_mfma_f32_16x16x32_bf16 a[24:27], v[128:131], a[224:227], a[24:27]
ds_read_b64_tr_b16 a[248:249], v7 offset:17120
v_mfma_f32_16x16x32_bf16 a[24:27], v[132:135], a[228:231], a[24:27]
v_exp_f32 v53, v53
v_mfma_f32_16x16x32_bf16 a[24:27], v[136:139], a[232:235], a[24:27]
ds_read_b64_tr_b16 a[250:251], v7 offset:17376
v_perm_b32 v220, v53, v52, s84
v_mfma_f32_16x16x32_bf16 a[24:27], v[140:143], a[236:239], a[24:27]
v_exp_f32 v54, v54
v_mfma_f32_16x16x32_bf16 a[56:59], v[156:159], a[236:239], a[56:59]
ds_read_b64_tr_b16 a[252:253], v7 offset:17632
v_mfma_f32_16x16x32_bf16 a[56:59], v[152:155], a[232:235], a[56:59]
v_exp_f32 v55, v55
v_mfma_f32_16x16x32_bf16 a[56:59], v[148:151], a[228:231], a[56:59]
ds_read_b64_tr_b16 a[254:255], v7 offset:17888
v_perm_b32 v221, v55, v54, s84
v_mfma_f32_16x16x32_bf16 a[56:59], v[144:147], a[224:227], a[56:59]
s_add_u32 m0, s22, 33792
v_exp_f32 v56, v56
v_mfma_f32_16x16x32_bf16 a[88:91], v[160:163], a[224:227], a[88:91]
buffer_load_dwordx4 v2, s[8:11], s20 offen offset:0 nt lds
v_mfma_f32_16x16x32_bf16 a[88:91], v[164:167], a[228:231], a[88:91]
v_exp_f32 v57, v57
v_mfma_f32_16x16x32_bf16 a[88:91], v[168:171], a[232:235], a[88:91]
v_perm_b32 v236, v57, v56, s84
v_mfma_f32_16x16x32_bf16 a[88:91], v[172:175], a[236:239], a[88:91]
v_exp_f32 v58, v58
v_mfma_f32_16x16x32_bf16 a[120:123], v[188:191], a[236:239], a[120:123]
buffer_load_dwordx4 v3, s[8:11], s20 offen offset:1056 nt lds
v_mfma_f32_16x16x32_bf16 a[120:123], v[184:187], a[232:235], a[120:123]
v_exp_f32 v59, v59
v_mfma_f32_16x16x32_bf16 a[120:123], v[180:183], a[228:231], a[120:123]
s_waitcnt vmcnt(4)
v_perm_b32 v237, v59, v58, s84
v_mfma_f32_16x16x32_bf16 a[120:123], v[176:179], a[224:227], a[120:123]
s_waitcnt vmcnt(6) lgkmcnt(0)
v_exp_f32 v60, v60
v_mfma_f32_16x16x32_bf16 v[48:51], a[208:211], a[128:131], v[64:67]
s_barrier
ds_read_b128 a[192:195], v6 offset:0
v_mfma_f32_16x16x32_bf16 v[48:51], a[212:215], a[132:135], v[48:51]
v_exp_f32 v61, v61
v_mfma_f32_16x16x32_bf16 v[48:51], a[216:219], a[136:139], v[48:51]
ds_read_b128 a[196:199], v6 offset:64
v_perm_b32 v252, v61, v60, s84
v_mfma_f32_16x16x32_bf16 v[48:51], a[220:223], a[140:143], v[48:51]
v_exp_f32 v62, v62
v_mfma_f32_16x16x32_bf16 v[52:55], a[220:223], a[156:159], v[68:71]
ds_read_b128 a[200:203], v6 offset:128
v_mfma_f32_16x16x32_bf16 v[52:55], a[216:219], a[152:155], v[52:55]
v_exp_f32 v63, v63
v_mfma_f32_16x16x32_bf16 v[52:55], a[212:215], a[148:151], v[52:55]
ds_read_b128 a[204:207], v6 offset:192
v_perm_b32 v253, v63, v62, s84
v_mfma_f32_16x16x32_bf16 v[52:55], a[208:211], a[144:147], v[52:55]
v_exp_f32 v48, v48
v_mfma_f32_16x16x32_bf16 v[56:59], a[208:211], a[160:163], v[72:75]
ds_read_b64_tr_b16 a[224:225], v7 offset:33792
v_mfma_f32_16x16x32_bf16 v[56:59], a[212:215], a[164:167], v[56:59]
v_exp_f32 v49, v49
v_mfma_f32_16x16x32_bf16 v[56:59], a[216:219], a[168:171], v[56:59]
ds_read_b64_tr_b16 a[226:227], v7 offset:34048
v_perm_b32 v206, v49, v48, s84
v_mfma_f32_16x16x32_bf16 v[56:59], a[220:223], a[172:175], v[56:59]
v_exp_f32 v50, v50
v_mfma_f32_16x16x32_bf16 v[60:63], a[220:223], a[188:191], v[76:79]
ds_read_b64_tr_b16 a[228:229], v7 offset:34304
v_mfma_f32_16x16x32_bf16 v[60:63], a[216:219], a[184:187], v[60:63]
v_exp_f32 v51, v51
v_mfma_f32_16x16x32_bf16 v[60:63], a[212:215], a[180:183], v[60:63]
ds_read_b64_tr_b16 a[230:231], v7 offset:34560
v_perm_b32 v207, v51, v50, s84
v_mfma_f32_16x16x32_bf16 v[60:63], a[208:211], a[176:179], v[60:63]
v_exp_f32 v52, v52
v_smfmac_f32_16x16x64_bf16 v[96:99], v[80:83], v[176:183], v45
v_smfmac_f32_16x16x64_bf16 v[96:99], v[80:83], v[184:191], v45
v_mfma_f32_16x16x32_bf16 a[28:31], v[128:131], a[240:243], a[28:31]
ds_read_b64_tr_b16 a[232:233], v7 offset:50688
v_mfma_f32_16x16x32_bf16 a[28:31], v[132:135], a[244:247], a[28:31]
v_exp_f32 v53, v53
v_mfma_f32_16x16x32_bf16 a[28:31], v[136:139], a[248:251], a[28:31]
ds_read_b64_tr_b16 a[234:235], v7 offset:50944
v_perm_b32 v222, v53, v52, s84
v_mfma_f32_16x16x32_bf16 a[28:31], v[140:143], a[252:255], a[28:31]
v_exp_f32 v54, v54
v_mfma_f32_16x16x32_bf16 a[60:63], v[156:159], a[252:255], a[60:63]
ds_read_b64_tr_b16 a[236:237], v7 offset:51200
v_mfma_f32_16x16x32_bf16 a[60:63], v[152:155], a[248:251], a[60:63]
v_exp_f32 v55, v55
v_mfma_f32_16x16x32_bf16 a[60:63], v[148:151], a[244:247], a[60:63]
ds_read_b64_tr_b16 a[238:239], v7 offset:51456
v_perm_b32 v223, v55, v54, s84
v_mfma_f32_16x16x32_bf16 a[60:63], v[144:147], a[240:243], a[60:63]
v_exp_f32 v56, v56
v_mfma_f32_16x16x32_bf16 a[92:95], v[160:163], a[240:243], a[92:95]
buffer_load_dwordx4 v4, s[8:11], s20 offen offset:2112 nt lds
v_mfma_f32_16x16x32_bf16 a[92:95], v[164:167], a[244:247], a[92:95]
v_exp_f32 v57, v57
v_mfma_f32_16x16x32_bf16 a[92:95], v[168:171], a[248:251], a[92:95]
v_perm_b32 v238, v57, v56, s84
v_mfma_f32_16x16x32_bf16 a[92:95], v[172:175], a[252:255], a[92:95]
v_exp_f32 v58, v58
v_mfma_f32_16x16x32_bf16 a[124:127], v[188:191], a[252:255], a[124:127]
buffer_load_dwordx4 v5, s[8:11], s20 offen offset:3168 nt lds
v_mfma_f32_16x16x32_bf16 a[124:127], v[184:187], a[248:251], a[124:127]
s_xor_b32 s20, s20, 8192
v_exp_f32 v59, v59
v_mfma_f32_16x16x32_bf16 a[124:127], v[180:183], a[244:247], a[124:127]
s_waitcnt vmcnt(4)
s_sub_u32 s23, s23, 1
v_perm_b32 v239, v59, v58, s84
v_mfma_f32_16x16x32_bf16 a[124:127], v[176:179], a[240:243], a[124:127]
s_waitcnt lgkmcnt(0)
v_exp_f32 v60, v60
s_cbranch_scc1 L_tail
v_mfma_f32_16x16x32_bf16 v[48:51], a[192:195], a[128:131], v[64:67]
ds_read_b128 a[208:211], v6 offset:256
v_mfma_f32_16x16x32_bf16 v[48:51], a[196:199], a[132:135], v[48:51]
v_exp_f32 v61, v61
v_mfma_f32_16x16x32_bf16 v[48:51], a[200:203], a[136:139], v[48:51]
ds_read_b128 a[212:215], v6 offset:320
v_perm_b32 v254, v61, v60, s84
v_mfma_f32_16x16x32_bf16 v[48:51], a[204:207], a[140:143], v[48:51]
v_exp_f32 v62, v62
v_mfma_f32_16x16x32_bf16 v[52:55], a[204:207], a[156:159], v[68:71]
ds_read_b128 a[216:219], v6 offset:384
v_mfma_f32_16x16x32_bf16 v[52:55], a[200:203], a[152:155], v[52:55]
v_exp_f32 v63, v63
v_mfma_f32_16x16x32_bf16 v[52:55], a[196:199], a[148:151], v[52:55]
ds_read_b128 a[220:223], v6 offset:448
v_perm_b32 v255, v63, v62, s84
v_mfma_f32_16x16x32_bf16 v[52:55], a[192:195], a[144:147], v[52:55]
v_exp_f32 v48, v48
v_mfma_f32_16x16x32_bf16 v[56:59], a[192:195], a[160:163], v[72:75]
ds_read_b64_tr_b16 a[240:241], v7 offset:33824
v_mfma_f32_16x16x32_bf16 v[56:59], a[196:199], a[164:167], v[56:59]
v_exp_f32 v49, v49
v_mfma_f32_16x16x32_bf16 v[56:59], a[200:203], a[168:171], v[56:59]
ds_read_b64_tr_b16 a[242:243], v7 offset:34080
v_perm_b32 v128, v49, v48, s84
v_mfma_f32_16x16x32_bf16 v[56:59], a[204:207], a[172:175], v[56:59]
v_exp_f32 v50, v50
v_mfma_f32_16x16x32_bf16 v[60:63], a[204:207], a[188:191], v[76:79]
ds_read_b64_tr_b16 a[244:245], v7 offset:34336
v_mfma_f32_16x16x32_bf16 v[60:63], a[200:203], a[184:187], v[60:63]
v_exp_f32 v51, v51
v_mfma_f32_16x16x32_bf16 v[60:63], a[196:199], a[180:183], v[60:63]
ds_read_b64_tr_b16 a[246:247], v7 offset:34592
v_perm_b32 v129, v51, v50, s84
v_mfma_f32_16x16x32_bf16 v[60:63], a[192:195], a[176:179], v[60:63]
v_exp_f32 v52, v52
v_mfma_f32_16x16x32_bf16 a[0:3], v[192:195], a[224:227], a[0:3]
ds_read_b64_tr_b16 a[248:249], v7 offset:50720
v_mfma_f32_16x16x32_bf16 a[0:3], v[196:199], a[228:231], a[0:3]
v_exp_f32 v53, v53
v_mfma_f32_16x16x32_bf16 a[0:3], v[200:203], a[232:235], a[0:3]
ds_read_b64_tr_b16 a[250:251], v7 offset:50976
v_perm_b32 v144, v53, v52, s84
v_mfma_f32_16x16x32_bf16 a[0:3], v[204:207], a[236:239], a[0:3]
v_exp_f32 v54, v54
v_mfma_f32_16x16x32_bf16 a[32:35], v[220:223], a[236:239], a[32:35]
ds_read_b64_tr_b16 a[252:253], v7 offset:51232
v_mfma_f32_16x16x32_bf16 a[32:35], v[216:219], a[232:235], a[32:35]
v_exp_f32 v55, v55
v_mfma_f32_16x16x32_bf16 a[32:35], v[212:215], a[228:231], a[32:35]
ds_read_b64_tr_b16 a[254:255], v7 offset:51488
v_perm_b32 v145, v55, v54, s84
v_mfma_f32_16x16x32_bf16 a[32:35], v[208:211], a[224:227], a[32:35]
s_add_u32 m0, s22, 67584
v_exp_f32 v56, v56
v_mfma_f32_16x16x32_bf16 a[64:67], v[224:227], a[224:227], a[64:67]
buffer_load_dwordx4 v2, s[12:15], s21 offen offset:0 nt lds
v_mfma_f32_16x16x32_bf16 a[64:67], v[228:231], a[228:231], a[64:67]
v_exp_f32 v57, v57
v_mfma_f32_16x16x32_bf16 a[64:67], v[232:235], a[232:235], a[64:67]
v_perm_b32 v160, v57, v56, s84
v_mfma_f32_16x16x32_bf16 a[64:67], v[236:239], a[236:239], a[64:67]
v_exp_f32 v58, v58
v_mfma_f32_16x16x32_bf16 a[96:99], v[252:255], a[236:239], a[96:99]
buffer_load_dwordx4 v3, s[12:15], s21 offen offset:1056 nt lds
v_mfma_f32_16x16x32_bf16 a[96:99], v[248:251], a[232:235], a[96:99]
v_exp_f32 v59, v59
v_mfma_f32_16x16x32_bf16 a[96:99], v[244:247], a[228:231], a[96:99]
s_waitcnt vmcnt(4)
v_perm_b32 v161, v59, v58, s84
v_mfma_f32_16x16x32_bf16 a[96:99], v[240:243], a[224:227], a[96:99]
s_waitcnt lgkmcnt(0)
v_exp_f32 v60, v60
v_mfma_f32_16x16x32_bf16 v[48:51], a[208:211], a[128:131], v[64:67]
ds_read_b128 a[192:195], v6 offset:512
v_mfma_f32_16x16x32_bf16 v[48:51], a[212:215], a[132:135], v[48:51]
v_exp_f32 v61, v61
v_mfma_f32_16x16x32_bf16 v[48:51], a[216:219], a[136:139], v[48:51]
ds_read_b128 a[196:199], v6 offset:576
v_perm_b32 v176, v61, v60, s84
v_mfma_f32_16x16x32_bf16 v[48:51], a[220:223], a[140:143], v[48:51]
v_exp_f32 v62, v62
v_mfma_f32_16x16x32_bf16 v[52:55], a[220:223], a[156:159], v[68:71]
ds_read_b128 a[200:203], v6 offset:640
v_mfma_f32_16x16x32_bf16 v[52:55], a[216:219], a[152:155], v[52:55]
v_exp_f32 v63, v63
v_mfma_f32_16x16x32_bf16 v[52:55], a[212:215], a[148:151], v[52:55]
ds_read_b128 a[204:207], v6 offset:704
v_perm_b32 v177, v63, v62, s84
v_mfma_f32_16x16x32_bf16 v[52:55], a[208:211], a[144:147], v[52:55]
v_exp_f32 v48, v48
v_mfma_f32_16x16x32_bf16 v[56:59], a[208:211], a[160:163], v[72:75]
ds_read_b64_tr_b16 a[224:225], v7 offset:33856
v_mfma_f32_16x16x32_bf16 v[56:59], a[212:215], a[164:167], v[56:59]
v_exp_f32 v49, v49
v_mfma_f32_16x16x32_bf16 v[56:59], a[216:219], a[168:171], v[56:59]
ds_read_b64_tr_b16 a[226:227], v7 offset:34112
v_perm_b32 v130, v49, v48, s84
v_mfma_f32_16x16x32_bf16 v[56:59], a[220:223], a[172:175], v[56:59]
v_exp_f32 v50, v50
v_mfma_f32_16x16x32_bf16 v[60:63], a[220:223], a[188:191], v[76:79]
ds_read_b64_tr_b16 a[228:229], v7 offset:34368
v_mfma_f32_16x16x32_bf16 v[60:63], a[216:219], a[184:187], v[60:63]
v_exp_f32 v51, v51
v_mfma_f32_16x16x32_bf16 v[60:63], a[212:215], a[180:183], v[60:63]
ds_read_b64_tr_b16 a[230:231], v7 offset:34624
v_perm_b32 v131, v51, v50, s84
v_mfma_f32_16x16x32_bf16 v[60:63], a[208:211], a[176:179], v[60:63]
v_exp_f32 v52, v52
v_smfmac_f32_16x16x64_bf16 v[84:87], v[80:83], v[192:199], v45
v_smfmac_f32_16x16x64_bf16 v[84:87], v[80:83], v[200:207], v45
v_mfma_f32_16x16x32_bf16 a[4:7], v[192:195], a[240:243], a[4:7]
ds_read_b64_tr_b16 a[232:233], v7 offset:50752
v_mfma_f32_16x16x32_bf16 a[4:7], v[196:199], a[244:247], a[4:7]
v_exp_f32 v53, v53
v_mfma_f32_16x16x32_bf16 a[4:7], v[200:203], a[248:251], a[4:7]
ds_read_b64_tr_b16 a[234:235], v7 offset:51008
v_perm_b32 v146, v53, v52, s84
v_mfma_f32_16x16x32_bf16 a[4:7], v[204:207], a[252:255], a[4:7]
v_exp_f32 v54, v54
v_mfma_f32_16x16x32_bf16 a[36:39], v[220:223], a[252:255], a[36:39]
ds_read_b64_tr_b16 a[236:237], v7 offset:51264
v_mfma_f32_16x16x32_bf16 a[36:39], v[216:219], a[248:251], a[36:39]
v_exp_f32 v55, v55
v_mfma_f32_16x16x32_bf16 a[36:39], v[212:215], a[244:247], a[36:39]
ds_read_b64_tr_b16 a[238:239], v7 offset:51520
v_perm_b32 v147, v55, v54, s84
v_mfma_f32_16x16x32_bf16 a[36:39], v[208:211], a[240:243], a[36:39]
v_exp_f32 v56, v56
v_mfma_f32_16x16x32_bf16 a[68:71], v[224:227], a[240:243], a[68:71]
buffer_load_dwordx4 v4, s[12:15], s21 offen offset:2112 nt lds
v_mfma_f32_16x16x32_bf16 a[68:71], v[228:231], a[244:247], a[68:71]
v_exp_f32 v57, v57
v_mfma_f32_16x16x32_bf16 a[68:71], v[232:235], a[248:251], a[68:71]
v_perm_b32 v162, v57, v56, s84
v_mfma_f32_16x16x32_bf16 a[68:71], v[236:239], a[252:255], a[68:71]
v_exp_f32 v58, v58
v_mfma_f32_16x16x32_bf16 a[100:103], v[252:255], a[252:255], a[100:103]
buffer_load_dwordx4 v5, s[12:15], s21 offen offset:3168 nt lds
v_mfma_f32_16x16x32_bf16 a[100:103], v[248:251], a[248:251], a[100:103]
s_xor_b32 s21, s21, 8192
v_exp_f32 v59, v59
v_mfma_f32_16x16x32_bf16 a[100:103], v[244:247], a[244:247], a[100:103]
s_waitcnt vmcnt(4)
v_perm_b32 v163, v59, v58, s84
v_mfma_f32_16x16x32_bf16 a[100:103], v[240:243], a[240:243], a[100:103]
s_waitcnt lgkmcnt(0)
v_exp_f32 v60, v60
v_mfma_f32_16x16x32_bf16 v[48:51], a[192:195], a[128:131], v[64:67]
ds_read_b128 a[208:211], v6 offset:768
v_mfma_f32_16x16x32_bf16 v[48:51], a[196:199], a[132:135], v[48:51]
v_exp_f32 v61, v61
v_mfma_f32_16x16x32_bf16 v[48:51], a[200:203], a[136:139], v[48:51]
ds_read_b128 a[212:215], v6 offset:832
v_perm_b32 v178, v61, v60, s84
v_mfma_f32_16x16x32_bf16 v[48:51], a[204:207], a[140:143], v[48:51]
v_exp_f32 v62, v62
v_mfma_f32_16x16x32_bf16 v[52:55], a[204:207], a[156:159], v[68:71]
ds_read_b128 a[216:219], v6 offset:896
v_mfma_f32_16x16x32_bf16 v[52:55], a[200:203], a[152:155], v[52:55]
v_exp_f32 v63, v63
v_mfma_f32_16x16x32_bf16 v[52:55], a[196:199], a[148:151], v[52:55]
ds_read_b128 a[220:223], v6 offset:960
v_perm_b32 v179, v63, v62, s84
v_mfma_f32_16x16x32_bf16 v[52:55], a[192:195], a[144:147], v[52:55]
v_exp_f32 v48, v48
v_mfma_f32_16x16x32_bf16 v[56:59], a[192:195], a[160:163], v[72:75]
ds_read_b64_tr_b16 a[240:241], v7 offset:33888
v_mfma_f32_16x16x32_bf16 v[56:59], a[196:199], a[164:167], v[56:59]
v_exp_f32 v49, v49
v_mfma_f32_16x16x32_bf16 v[56:59], a[200:203], a[168:171], v[56:59]
ds_read_b64_tr_b16 a[242:243], v7 offset:34144
v_perm_b32 v132, v49, v48, s84
v_mfma_f32_16x16x32_bf16 v[56:59], a[204:207], a[172:175], v[56:59]
v_exp_f32 v50, v50
v_mfma_f32_16x16x32_bf16 v[60:63], a[204:207], a[188:191], v[76:79]
ds_read_b64_tr_b16 a[244:245], v7 offset:34400
v_mfma_f32_16x16x32_bf16 v[60:63], a[200:203], a[184:187], v[60:63]
v_exp_f32 v51, v51
v_mfma_f32_16x16x32_bf16 v[60:63], a[196:199], a[180:183], v[60:63]
ds_read_b64_tr_b16 a[246:247], v7 offset:34656
v_perm_b32 v133, v51, v50, s84
v_mfma_f32_16x16x32_bf16 v[60:63], a[192:195], a[176:179], v[60:63]
v_exp_f32 v52, v52
v_mfma_f32_16x16x32_bf16 a[8:11], v[192:195], a[224:227], a[8:11]
ds_read_b64_tr_b16 a[248:249], v7 offset:50784
v_mfma_f32_16x16x32_bf16 a[8:11], v[196:199], a[228:231], a[8:11]
v_exp_f32 v53, v53
v_mfma_f32_16x16x32_bf16 a[8:11], v[200:203], a[232:235], a[8:11]
ds_read_b64_tr_b16 a[250:251], v7 offset:51040
v_perm_b32 v148, v53, v52, s84
v_mfma_f32_16x16x32_bf16 a[8:11], v[204:207], a[236:239], a[8:11]
v_exp_f32 v54, v54
v_mfma_f32_16x16x32_bf16 a[40:43], v[220:223], a[236:239], a[40:43]
ds_read_b64_tr_b16 a[252:253], v7 offset:51296
v_mfma_f32_16x16x32_bf16 a[40:43], v[216:219], a[232:235], a[40:43]
v_exp_f32 v55, v55
v_mfma_f32_16x16x32_bf16 a[40:43], v[212:215], a[228:231], a[40:43]
ds_read_b64_tr_b16 a[254:255], v7 offset:51552
v_perm_b32 v149, v55, v54, s84
v_mfma_f32_16x16x32_bf16 a[40:43], v[208:211], a[224:227], a[40:43]
s_add_u32 m0, s22, 84480
v_exp_f32 v56, v56
v_mfma_f32_16x16x32_bf16 a[72:75], v[224:227], a[224:227], a[72:75]
buffer_load_dwordx4 v2, s[12:15], s21 offen offset:0 nt lds
v_mfma_f32_16x16x32_bf16 a[72:75], v[228:231], a[228:231], a[72:75]
v_exp_f32 v57, v57
v_mfma_f32_16x16x32_bf16 a[72:75], v[232:235], a[232:235], a[72:75]
v_perm_b32 v164, v57, v56, s84
v_mfma_f32_16x16x32_bf16 a[72:75], v[236:239], a[236:239], a[72:75]
v_exp_f32 v58, v58
v_mfma_f32_16x16x32_bf16 a[104:107], v[252:255], a[236:239], a[104:107]
buffer_load_dwordx4 v3, s[12:15], s21 offen offset:1056 nt lds
v_mfma_f32_16x16x32_bf16 a[104:107], v[248:251], a[232:235], a[104:107]
v_exp_f32 v59, v59
v_mfma_f32_16x16x32_bf16 a[104:107], v[244:247], a[228:231], a[104:107]
s_waitcnt vmcnt(4)
v_perm_b32 v165, v59, v58, s84
v_mfma_f32_16x16x32_bf16 a[104:107], v[240:243], a[224:227], a[104:107]
s_waitcnt vmcnt(10) lgkmcnt(0)
v_exp_f32 v60, v60
v_mfma_f32_16x16x32_bf16 v[48:51], a[208:211], a[128:131], v[64:67]
s_barrier
ds_read_b128 a[192:195], v6 offset:16896
v_mfma_f32_16x16x32_bf16 v[48:51], a[212:215], a[132:135], v[48:51]
v_exp_f32 v61, v61
v_mfma_f32_16x16x32_bf16 v[48:51], a[216:219], a[136:139], v[48:51]
ds_read_b128 a[196:199], v6 offset:16960
v_perm_b32 v180, v61, v60, s84
v_mfma_f32_16x16x32_bf16 v[48:51], a[220:223], a[140:143], v[48:51]
v_exp_f32 v62, v62
v_mfma_f32_16x16x32_bf16 v[52:55], a[220:223], a[156:159], v[68:71]
ds_read_b128 a[200:203], v6 offset:17024
v_mfma_f32_16x16x32_bf16 v[52:55], a[216:219], a[152:155], v[52:55]
v_exp_f32 v63, v63
v_mfma_f32_16x16x32_bf16 v[52:55], a[212:215], a[148:151], v[52:55]
ds_read_b128 a[204:207], v6 offset:17088
v_perm_b32 v181, v63, v62, s84
v_mfma_f32_16x16x32_bf16 v[52:55], a[208:211], a[144:147], v[52:55]
v_exp_f32 v48, v48
v_mfma_f32_16x16x32_bf16 v[56:59], a[208:211], a[160:163], v[72:75]
ds_read_b64_tr_b16 a[224:225], v7 offset:33920
v_mfma_f32_16x16x32_bf16 v[56:59], a[212:215], a[164:167], v[56:59]
v_exp_f32 v49, v49
v_mfma_f32_16x16x32_bf16 v[56:59], a[216:219], a[168:171], v[56:59]
ds_read_b64_tr_b16 a[226:227], v7 offset:34176
v_perm_b32 v134, v49, v48, s84
v_mfma_f32_16x16x32_bf16 v[56:59], a[220:223], a[172:175], v[56:59]
v_exp_f32 v50, v50
v_mfma_f32_16x16x32_bf16 v[60:63], a[220:223], a[188:191], v[76:79]
ds_read_b64_tr_b16 a[228:229], v7 offset:34432
v_mfma_f32_16x16x32_bf16 v[60:63], a[216:219], a[184:187], v[60:63]
v_exp_f32 v51, v51
v_mfma_f32_16x16x32_bf16 v[60:63], a[212:215], a[180:183], v[60:63]
ds_read_b64_tr_b16 a[230:231], v7 offset:34688
v_perm_b32 v135, v51, v50, s84
v_mfma_f32_16x16x32_bf16 v[60:63], a[208:211], a[176:179], v[60:63]
v_exp_f32 v52, v52
v_smfmac_f32_16x16x64_bf16 v[88:91], v[80:83], v[208:215], v45
v_smfmac_f32_16x16x64_bf16 v[88:91], v[80:83], v[216:223], v45
v_mfma_f32_16x16x32_bf16 a[12:15], v[192:195], a[240:243], a[12:15]
ds_read_b64_tr_b16 a[232:233], v7 offset:50816
v_mfma_f32_16x16x32_bf16 a[12:15], v[196:199], a[244:247], a[12:15]
v_exp_f32 v53, v53
v_mfma_f32_16x16x32_bf16 a[12:15], v[200:203], a[248:251], a[12:15]
ds_read_b64_tr_b16 a[234:235], v7 offset:51072
v_perm_b32 v150, v53, v52, s84
v_mfma_f32_16x16x32_bf16 a[12:15], v[204:207], a[252:255], a[12:15]
v_exp_f32 v54, v54
v_mfma_f32_16x16x32_bf16 a[44:47], v[220:223], a[252:255], a[44:47]
ds_read_b64_tr_b16 a[236:237], v7 offset:51328
v_mfma_f32_16x16x32_bf16 a[44:47], v[216:219], a[248:251], a[44:47]
v_exp_f32 v55, v55
v_mfma_f32_16x16x32_bf16 a[44:47], v[212:215], a[244:247], a[44:47]
ds_read_b64_tr_b16 a[238:239], v7 offset:51584
v_perm_b32 v151, v55, v54, s84
v_mfma_f32_16x16x32_bf16 a[44:47], v[208:211], a[240:243], a[44:47]
v_exp_f32 v56, v56
v_mfma_f32_16x16x32_bf16 a[76:79], v[224:227], a[240:243], a[76:79]
buffer_load_dwordx4 v4, s[12:15], s21 offen offset:2112 nt lds
v_mfma_f32_16x16x32_bf16 a[76:79], v[228:231], a[244:247], a[76:79]
v_exp_f32 v57, v57
v_mfma_f32_16x16x32_bf16 a[76:79], v[232:235], a[248:251], a[76:79]
v_perm_b32 v166, v57, v56, s84
v_mfma_f32_16x16x32_bf16 a[76:79], v[236:239], a[252:255], a[76:79]
v_exp_f32 v58, v58
v_mfma_f32_16x16x32_bf16 a[108:111], v[252:255], a[252:255], a[108:111]
buffer_load_dwordx4 v5, s[12:15], s21 offen offset:3168 nt lds
v_mfma_f32_16x16x32_bf16 a[108:111], v[248:251], a[248:251], a[108:111]
s_xor_b32 s21, s21, 24576
v_exp_f32 v59, v59
v_mfma_f32_16x16x32_bf16 a[108:111], v[244:247], a[244:247], a[108:111]
s_waitcnt vmcnt(4)
v_perm_b32 v167, v59, v58, s84
v_mfma_f32_16x16x32_bf16 a[108:111], v[240:243], a[240:243], a[108:111]
s_waitcnt lgkmcnt(0)
v_exp_f32 v60, v60
v_mfma_f32_16x16x32_bf16 v[48:51], a[192:195], a[128:131], v[64:67]
ds_read_b128 a[208:211], v6 offset:17152
v_mfma_f32_16x16x32_bf16 v[48:51], a[196:199], a[132:135], v[48:51]
v_exp_f32 v61, v61
v_mfma_f32_16x16x32_bf16 v[48:51], a[200:203], a[136:139], v[48:51]
ds_read_b128 a[212:215], v6 offset:17216
v_perm_b32 v182, v61, v60, s84
v_mfma_f32_16x16x32_bf16 v[48:51], a[204:207], a[140:143], v[48:51]
v_exp_f32 v62, v62
v_mfma_f32_16x16x32_bf16 v[52:55], a[204:207], a[156:159], v[68:71]
ds_read_b128 a[216:219], v6 offset:17280
v_mfma_f32_16x16x32_bf16 v[52:55], a[200:203], a[152:155], v[52:55]
v_exp_f32 v63, v63
v_mfma_f32_16x16x32_bf16 v[52:55], a[196:199], a[148:151], v[52:55]
ds_read_b128 a[220:223], v6 offset:17344
v_perm_b32 v183, v63, v62, s84
v_mfma_f32_16x16x32_bf16 v[52:55], a[192:195], a[144:147], v[52:55]
v_exp_f32 v48, v48
v_mfma_f32_16x16x32_bf16 v[56:59], a[192:195], a[160:163], v[72:75]
ds_read_b64_tr_b16 a[240:241], v7 offset:33952
v_mfma_f32_16x16x32_bf16 v[56:59], a[196:199], a[164:167], v[56:59]
v_exp_f32 v49, v49
v_mfma_f32_16x16x32_bf16 v[56:59], a[200:203], a[168:171], v[56:59]
ds_read_b64_tr_b16 a[242:243], v7 offset:34208
v_perm_b32 v136, v49, v48, s84
v_mfma_f32_16x16x32_bf16 v[56:59], a[204:207], a[172:175], v[56:59]
v_exp_f32 v50, v50
v_mfma_f32_16x16x32_bf16 v[60:63], a[204:207], a[188:191], v[76:79]
ds_read_b64_tr_b16 a[244:245], v7 offset:34464
v_mfma_f32_16x16x32_bf16 v[60:63], a[200:203], a[184:187], v[60:63]
v_exp_f32 v51, v51
v_mfma_f32_16x16x32_bf16 v[60:63], a[196:199], a[180:183], v[60:63]
ds_read_b64_tr_b16 a[246:247], v7 offset:34720
v_perm_b32 v137, v51, v50, s84
v_mfma_f32_16x16x32_bf16 v[60:63], a[192:195], a[176:179], v[60:63]
v_exp_f32 v52, v52
v_mfma_f32_16x16x32_bf16 a[16:19], v[192:195], a[224:227], a[16:19]
ds_read_b64_tr_b16 a[248:249], v7 offset:50848
v_mfma_f32_16x16x32_bf16 a[16:19], v[196:199], a[228:231], a[16:19]
v_exp_f32 v53, v53
v_mfma_f32_16x16x32_bf16 a[16:19], v[200:203], a[232:235], a[16:19]
ds_read_b64_tr_b16 a[250:251], v7 offset:51104
v_perm_b32 v152, v53, v52, s84
v_mfma_f32_16x16x32_bf16 a[16:19], v[204:207], a[236:239], a[16:19]
v_exp_f32 v54, v54
v_mfma_f32_16x16x32_bf16 a[48:51], v[220:223], a[236:239], a[48:51]
ds_read_b64_tr_b16 a[252:253], v7 offset:51360
v_mfma_f32_16x16x32_bf16 a[48:51], v[216:219], a[232:235], a[48:51]
v_exp_f32 v55, v55
v_mfma_f32_16x16x32_bf16 a[48:51], v[212:215], a[228:231], a[48:51]
ds_read_b64_tr_b16 a[254:255], v7 offset:51616
v_perm_b32 v153, v55, v54, s84
v_mfma_f32_16x16x32_bf16 a[48:51], v[208:211], a[224:227], a[48:51]
s_add_u32 m0, s22, 50688
v_exp_f32 v56, v56
v_mfma_f32_16x16x32_bf16 a[80:83], v[224:227], a[224:227], a[80:83]
buffer_load_dwordx4 v2, s[8:11], s20 offen offset:0 nt lds
v_mfma_f32_16x16x32_bf16 a[80:83], v[228:231], a[228:231], a[80:83]
v_exp_f32 v57, v57
v_mfma_f32_16x16x32_bf16 a[80:83], v[232:235], a[232:235], a[80:83]
v_perm_b32 v168, v57, v56, s84
v_mfma_f32_16x16x32_bf16 a[80:83], v[236:239], a[236:239], a[80:83]
v_exp_f32 v58, v58
v_mfma_f32_16x16x32_bf16 a[112:115], v[252:255], a[236:239], a[112:115]
buffer_load_dwordx4 v3, s[8:11], s20 offen offset:1056 nt lds
v_mfma_f32_16x16x32_bf16 a[112:115], v[248:251], a[232:235], a[112:115]
v_exp_f32 v59, v59
v_mfma_f32_16x16x32_bf16 a[112:115], v[244:247], a[228:231], a[112:115]
s_waitcnt vmcnt(4)
v_perm_b32 v169, v59, v58, s84
v_mfma_f32_16x16x32_bf16 a[112:115], v[240:243], a[224:227], a[112:115]
s_waitcnt lgkmcnt(0)
v_exp_f32 v60, v60
v_mfma_f32_16x16x32_bf16 v[48:51], a[208:211], a[128:131], v[64:67]
ds_read_b128 a[192:195], v6 offset:17408
v_mfma_f32_16x16x32_bf16 v[48:51], a[212:215], a[132:135], v[48:51]
v_exp_f32 v61, v61
v_mfma_f32_16x16x32_bf16 v[48:51], a[216:219], a[136:139], v[48:51]
ds_read_b128 a[196:199], v6 offset:17472
v_perm_b32 v184, v61, v60, s84
v_mfma_f32_16x16x32_bf16 v[48:51], a[220:223], a[140:143], v[48:51]
v_exp_f32 v62, v62
v_mfma_f32_16x16x32_bf16 v[52:55], a[220:223], a[156:159], v[68:71]
ds_read_b128 a[200:203], v6 offset:17536
v_mfma_f32_16x16x32_bf16 v[52:55], a[216:219], a[152:155], v[52:55]
v_exp_f32 v63, v63
v_mfma_f32_16x16x32_bf16 v[52:55], a[212:215], a[148:151], v[52:55]
ds_read_b128 a[204:207], v6 offset:17600
v_perm_b32 v185, v63, v62, s84
v_mfma_f32_16x16x32_bf16 v[52:55], a[208:211], a[144:147], v[52:55]
v_exp_f32 v48, v48
v_mfma_f32_16x16x32_bf16 v[56:59], a[208:211], a[160:163], v[72:75]
ds_read_b64_tr_b16 a[224:225], v7 offset:33984
v_mfma_f32_16x16x32_bf16 v[56:59], a[212:215], a[164:167], v[56:59]
v_exp_f32 v49, v49
v_mfma_f32_16x16x32_bf16 v[56:59], a[216:219], a[168:171], v[56:59]
ds_read_b64_tr_b16 a[226:227], v7 offset:34240
v_perm_b32 v138, v49, v48, s84
v_mfma_f32_16x16x32_bf16 v[56:59], a[220:223], a[172:175], v[56:59]
v_exp_f32 v50, v50
v_mfma_f32_16x16x32_bf16 v[60:63], a[220:223], a[188:191], v[76:79]
ds_read_b64_tr_b16 a[228:229], v7 offset:34496
v_mfma_f32_16x16x32_bf16 v[60:63], a[216:219], a[184:187], v[60:63]
v_exp_f32 v51, v51
v_mfma_f32_16x16x32_bf16 v[60:63], a[212:215], a[180:183], v[60:63]
ds_read_b64_tr_b16 a[230:231], v7 offset:34752
v_perm_b32 v139, v51, v50, s84
v_mfma_f32_16x16x32_bf16 v[60:63], a[208:211], a[176:179], v[60:63]
v_exp_f32 v52, v52
v_smfmac_f32_16x16x64_bf16 v[92:95], v[80:83], v[224:231], v45
v_smfmac_f32_16x16x64_bf16 v[92:95], v[80:83], v[232:239], v45
v_mfma_f32_16x16x32_bf16 a[20:23], v[192:195], a[240:243], a[20:23]
ds_read_b64_tr_b16 a[232:233], v7 offset:50880
v_mfma_f32_16x16x32_bf16 a[20:23], v[196:199], a[244:247], a[20:23]
v_exp_f32 v53, v53
v_mfma_f32_16x16x32_bf16 a[20:23], v[200:203], a[248:251], a[20:23]
ds_read_b64_tr_b16 a[234:235], v7 offset:51136
v_perm_b32 v154, v53, v52, s84
v_mfma_f32_16x16x32_bf16 a[20:23], v[204:207], a[252:255], a[20:23]
v_exp_f32 v54, v54
v_mfma_f32_16x16x32_bf16 a[52:55], v[220:223], a[252:255], a[52:55]
ds_read_b64_tr_b16 a[236:237], v7 offset:51392
v_mfma_f32_16x16x32_bf16 a[52:55], v[216:219], a[248:251], a[52:55]
v_exp_f32 v55, v55
v_mfma_f32_16x16x32_bf16 a[52:55], v[212:215], a[244:247], a[52:55]
ds_read_b64_tr_b16 a[238:239], v7 offset:51648
v_perm_b32 v155, v55, v54, s84
v_mfma_f32_16x16x32_bf16 a[52:55], v[208:211], a[240:243], a[52:55]
v_exp_f32 v56, v56
v_mfma_f32_16x16x32_bf16 a[84:87], v[224:227], a[240:243], a[84:87]
buffer_load_dwordx4 v4, s[8:11], s20 offen offset:2112 nt lds
v_mfma_f32_16x16x32_bf16 a[84:87], v[228:231], a[244:247], a[84:87]
v_exp_f32 v57, v57
v_mfma_f32_16x16x32_bf16 a[84:87], v[232:235], a[248:251], a[84:87]
v_perm_b32 v170, v57, v56, s84
v_mfma_f32_16x16x32_bf16 a[84:87], v[236:239], a[252:255], a[84:87]
v_exp_f32 v58, v58
v_mfma_f32_16x16x32_bf16 a[116:119], v[252:255], a[252:255], a[116:119]
buffer_load_dwordx4 v5, s[8:11], s20 offen offset:3168 nt lds
v_mfma_f32_16x16x32_bf16 a[116:119], v[248:251], a[248:251], a[116:119]
s_sub_u32 s95, s95, s96
s_and_b32 s95, s95, s96
s_add_u32 s20, s95, s97
v_exp_f32 v59, v59
v_mfma_f32_16x16x32_bf16 a[116:119], v[244:247], a[244:247], a[116:119]
s_waitcnt vmcnt(4)
v_perm_b32 v171, v59, v58, s84
v_mfma_f32_16x16x32_bf16 a[116:119], v[240:243], a[240:243], a[116:119]
s_waitcnt lgkmcnt(0)
v_exp_f32 v60, v60
v_mfma_f32_16x16x32_bf16 v[48:51], a[192:195], a[128:131], v[64:67]
ds_read_b128 a[208:211], v6 offset:17664
v_mfma_f32_16x16x32_bf16 v[48:51], a[196:199], a[132:135], v[48:51]
v_exp_f32 v61, v61
v_mfma_f32_16x16x32_bf16 v[48:51], a[200:203], a[136:139], v[48:51]
ds_read_b128 a[212:215], v6 offset:17728
v_perm_b32 v186, v61, v60, s84
v_mfma_f32_16x16x32_bf16 v[48:51], a[204:207], a[140:143], v[48:51]
v_exp_f32 v62, v62
v_mfma_f32_16x16x32_bf16 v[52:55], a[204:207], a[156:159], v[68:71]
ds_read_b128 a[216:219], v6 offset:17792
v_mfma_f32_16x16x32_bf16 v[52:55], a[200:203], a[152:155], v[52:55]
v_exp_f32 v63, v63
v_mfma_f32_16x16x32_bf16 v[52:55], a[196:199], a[148:151], v[52:55]
ds_read_b128 a[220:223], v6 offset:17856
v_perm_b32 v187, v63, v62, s84
v_mfma_f32_16x16x32_bf16 v[52:55], a[192:195], a[144:147], v[52:55]
v_exp_f32 v48, v48
v_mfma_f32_16x16x32_bf16 v[56:59], a[192:195], a[160:163], v[72:75]
ds_read_b64_tr_b16 a[240:241], v7 offset:34016
v_mfma_f32_16x16x32_bf16 v[56:59], a[196:199], a[164:167], v[56:59]
v_exp_f32 v49, v49
v_mfma_f32_16x16x32_bf16 v[56:59], a[200:203], a[168:171], v[56:59]
ds_read_b64_tr_b16 a[242:243], v7 offset:34272
v_perm_b32 v140, v49, v48, s84
v_mfma_f32_16x16x32_bf16 v[56:59], a[204:207], a[172:175], v[56:59]
v_exp_f32 v50, v50
v_mfma_f32_16x16x32_bf16 v[60:63], a[204:207], a[188:191], v[76:79]
ds_read_b64_tr_b16 a[244:245], v7 offset:34528
v_mfma_f32_16x16x32_bf16 v[60:63], a[200:203], a[184:187], v[60:63]
v_exp_f32 v51, v51
v_mfma_f32_16x16x32_bf16 v[60:63], a[196:199], a[180:183], v[60:63]
ds_read_b64_tr_b16 a[246:247], v7 offset:34784
v_perm_b32 v141, v51, v50, s84
v_mfma_f32_16x16x32_bf16 v[60:63], a[192:195], a[176:179], v[60:63]
v_exp_f32 v52, v52
v_mfma_f32_16x16x32_bf16 a[24:27], v[192:195], a[224:227], a[24:27]
ds_read_b64_tr_b16 a[248:249], v7 offset:50912
v_mfma_f32_16x16x32_bf16 a[24:27], v[196:199], a[228:231], a[24:27]
v_exp_f32 v53, v53
v_mfma_f32_16x16x32_bf16 a[24:27], v[200:203], a[232:235], a[24:27]
ds_read_b64_tr_b16 a[250:251], v7 offset:51168
v_perm_b32 v156, v53, v52, s84
v_mfma_f32_16x16x32_bf16 a[24:27], v[204:207], a[236:239], a[24:27]
v_exp_f32 v54, v54
v_mfma_f32_16x16x32_bf16 a[56:59], v[220:223], a[236:239], a[56:59]
ds_read_b64_tr_b16 a[252:253], v7 offset:51424
v_mfma_f32_16x16x32_bf16 a[56:59], v[216:219], a[232:235], a[56:59]
v_exp_f32 v55, v55
v_mfma_f32_16x16x32_bf16 a[56:59], v[212:215], a[228:231], a[56:59]
ds_read_b64_tr_b16 a[254:255], v7 offset:51680
v_perm_b32 v157, v55, v54, s84
v_mfma_f32_16x16x32_bf16 a[56:59], v[208:211], a[224:227], a[56:59]
s_add_u32 m0, s22, 0
v_exp_f32 v56, v56
v_mfma_f32_16x16x32_bf16 a[88:91], v[224:227], a[224:227], a[88:91]
buffer_load_dwordx4 v2, s[8:11], s20 offen offset:0 nt lds
v_mfma_f32_16x16x32_bf16 a[88:91], v[228:231], a[228:231], a[88:91]
v_exp_f32 v57, v57
v_mfma_f32_16x16x32_bf16 a[88:91], v[232:235], a[232:235], a[88:91]
v_perm_b32 v172, v57, v56, s84
v_mfma_f32_16x16x32_bf16 a[88:91], v[236:239], a[236:239], a[88:91]
v_exp_f32 v58, v58
v_mfma_f32_16x16x32_bf16 a[120:123], v[252:255], a[236:239], a[120:123]
buffer_load_dwordx4 v3, s[8:11], s20 offen offset:1056 nt lds
v_mfma_f32_16x16x32_bf16 a[120:123], v[248:251], a[232:235], a[120:123]
v_exp_f32 v59, v59
v_mfma_f32_16x16x32_bf16 a[120:123], v[244:247], a[228:231], a[120:123]
s_waitcnt vmcnt(4)
v_perm_b32 v173, v59, v58, s84
v_mfma_f32_16x16x32_bf16 a[120:123], v[240:243], a[224:227], a[120:123]
s_waitcnt vmcnt(6) lgkmcnt(0)
v_exp_f32 v60, v60
v_mfma_f32_16x16x32_bf16 v[48:51], a[208:211], a[128:131], v[64:67]
s_barrier
ds_read_b128 a[192:195], v6 offset:33792
v_mfma_f32_16x16x32_bf16 v[48:51], a[212:215], a[132:135], v[48:51]
v_exp_f32 v61, v61
v_mfma_f32_16x16x32_bf16 v[48:51], a[216:219], a[136:139], v[48:51]
ds_read_b128 a[196:199], v6 offset:33856
v_perm_b32 v188, v61, v60, s84
v_mfma_f32_16x16x32_bf16 v[48:51], a[220:223], a[140:143], v[48:51]
v_exp_f32 v62, v62
v_mfma_f32_16x16x32_bf16 v[52:55], a[220:223], a[156:159], v[68:71]
ds_read_b128 a[200:203], v6 offset:33920
v_mfma_f32_16x16x32_bf16 v[52:55], a[216:219], a[152:155], v[52:55]
v_exp_f32 v63, v63
v_mfma_f32_16x16x32_bf16 v[52:55], a[212:215], a[148:151], v[52:55]
ds_read_b128 a[204:207], v6 offset:33984
v_perm_b32 v189, v63, v62, s84
v_mfma_f32_16x16x32_bf16 v[52:55], a[208:211], a[144:147], v[52:55]
v_exp_f32 v48, v48
v_mfma_f32_16x16x32_bf16 v[56:59], a[208:211], a[160:163], v[72:75]
ds_read_b64_tr_b16 a[224:225], v7 offset:0
v_mfma_f32_16x16x32_bf16 v[56:59], a[212:215], a[164:167], v[56:59]
v_exp_f32 v49, v49
v_mfma_f32_16x16x32_bf16 v[56:59], a[216:219], a[168:171], v[56:59]
ds_read_b64_tr_b16 a[226:227], v7 offset:256
v_perm_b32 v142, v49, v48, s84
v_mfma_f32_16x16x32_bf16 v[56:59], a[220:223], a[172:175], v[56:59]
v_exp_f32 v50, v50
v_mfma_f32_16x16x32_bf16 v[60:63], a[220:223], a[188:191], v[76:79]
ds_read_b64_tr_b16 a[228:229], v7 offset:512
v_mfma_f32_16x16x32_bf16 v[60:63], a[216:219], a[184:187], v[60:63]
v_exp_f32 v51, v51
v_mfma_f32_16x16x32_bf16 v[60:63], a[212:215], a[180:183], v[60:63]
ds_read_b64_tr_b16 a[230:231], v7 offset:768
v_perm_b32 v143, v51, v50, s84
v_mfma_f32_16x16x32_bf16 v[60:63], a[208:211], a[176:179], v[60:63]
v_exp_f32 v52, v52
v_smfmac_f32_16x16x64_bf16 v[96:99], v[80:83], v[240:247], v45
v_smfmac_f32_16x16x64_bf16 v[96:99], v[80:83], v[248:255], v45
v_mfma_f32_16x16x32_bf16 a[28:31], v[192:195], a[240:243], a[28:31]
ds_read_b64_tr_b16 a[232:233], v7 offset:16896
v_mfma_f32_16x16x32_bf16 a[28:31], v[196:199], a[244:247], a[28:31]
v_exp_f32 v53, v53
v_mfma_f32_16x16x32_bf16 a[28:31], v[200:203], a[248:251], a[28:31]
ds_read_b64_tr_b16 a[234:235], v7 offset:17152
v_perm_b32 v158, v53, v52, s84
v_mfma_f32_16x16x32_bf16 a[28:31], v[204:207], a[252:255], a[28:31]
v_exp_f32 v54, v54
v_mfma_f32_16x16x32_bf16 a[60:63], v[220:223], a[252:255], a[60:63]
ds_read_b64_tr_b16 a[236:237], v7 offset:17408
v_mfma_f32_16x16x32_bf16 a[60:63], v[216:219], a[248:251], a[60:63]
v_exp_f32 v55, v55
v_mfma_f32_16x16x32_bf16 a[60:63], v[212:215], a[244:247], a[60:63]
ds_read_b64_tr_b16 a[238:239], v7 offset:17664
v_perm_b32 v159, v55, v54, s84
v_mfma_f32_16x16x32_bf16 a[60:63], v[208:211], a[240:243], a[60:63]
v_exp_f32 v56, v56
v_mfma_f32_16x16x32_bf16 a[92:95], v[224:227], a[240:243], a[92:95]
buffer_load_dwordx4 v4, s[8:11], s20 offen offset:2112 nt lds
v_mfma_f32_16x16x32_bf16 a[92:95], v[228:231], a[244:247], a[92:95]
v_exp_f32 v57, v57
v_mfma_f32_16x16x32_bf16 a[92:95], v[232:235], a[248:251], a[92:95]
v_perm_b32 v174, v57, v56, s84
v_mfma_f32_16x16x32_bf16 a[92:95], v[236:239], a[252:255], a[92:95]
v_exp_f32 v58, v58
v_mfma_f32_16x16x32_bf16 a[124:127], v[252:255], a[252:255], a[124:127]
buffer_load_dwordx4 v5, s[8:11], s20 offen offset:3168 nt lds
v_mfma_f32_16x16x32_bf16 a[124:127], v[248:251], a[248:251], a[124:127]
s_xor_b32 s20, s20, 8192
v_exp_f32 v59, v59
v_mfma_f32_16x16x32_bf16 a[124:127], v[244:247], a[244:247], a[124:127]
s_waitcnt vmcnt(4)
v_perm_b32 v175, v59, v58, s84
v_mfma_f32_16x16x32_bf16 a[124:127], v[240:243], a[240:243], a[124:127]
s_waitcnt lgkmcnt(0)
v_exp_f32 v60, v60
s_branch L_loop
L_tail:
v_mfma_f32_16x16x32_bf16 v[48:51], a[192:195], a[128:131], v[64:67]
ds_read_b128 a[208:211], v6 offset:256
v_mfma_f32_16x16x32_bf16 v[48:51], a[196:199], a[132:135], v[48:51]
v_exp_f32 v61, v61
v_mfma_f32_16x16x32_bf16 v[48:51], a[200:203], a[136:139], v[48:51]
ds_read_b128 a[212:215], v6 offset:320
v_perm_b32 v254, v61, v60, s84
v_mfma_f32_16x16x32_bf16 v[48:51], a[204:207], a[140:143], v[48:51]
v_exp_f32 v62, v62
v_mfma_f32_16x16x32_bf16 v[52:55], a[204:207], a[156:159], v[68:71]
ds_read_b128 a[216:219], v6 offset:384
v_mfma_f32_16x16x32_bf16 v[52:55], a[200:203], a[152:155], v[52:55]
v_exp_f32 v63, v63
v_mfma_f32_16x16x32_bf16 v[52:55], a[196:199], a[148:151], v[52:55]
ds_read_b128 a[220:223], v6 offset:448
v_perm_b32 v255, v63, v62, s84
v_mfma_f32_16x16x32_bf16 v[52:55], a[192:195], a[144:147], v[52:55]
v_exp_f32 v48, v48
v_mfma_f32_16x16x32_bf16 v[56:59], a[192:195], a[160:163], v[72:75]
ds_read_b64_tr_b16 a[240:241], v7 offset:33824
v_mfma_f32_16x16x32_bf16 v[56:59], a[196:199], a[164:167], v[56:59]
v_exp_f32 v49, v49
v_mfma_f32_16x16x32_bf16 v[56:59], a[200:203], a[168:171], v[56:59]
ds_read_b64_tr_b16 a[242:243], v7 offset:34080
v_perm_b32 v128, v49, v48, s84
v_mfma_f32_16x16x32_bf16 v[56:59], a[204:207], a[172:175], v[56:59]
v_exp_f32 v50, v50
v_mfma_f32_16x16x32_bf16 v[60:63], a[204:207], a[188:191], v[76:79]
ds_read_b64_tr_b16 a[244:245], v7 offset:34336
v_mfma_f32_16x16x32_bf16 v[60:63], a[200:203], a[184:187], v[60:63]
v_exp_f32 v51, v51
v_mfma_f32_16x16x32_bf16 v[60:63], a[196:199], a[180:183], v[60:63]
ds_read_b64_tr_b16 a[246:247], v7 offset:34592
v_perm_b32 v129, v51, v50, s84
v_mfma_f32_16x16x32_bf16 v[60:63], a[192:195], a[176:179], v[60:63]
v_exp_f32 v52, v52
v_mfma_f32_16x16x32_bf16 a[0:3], v[192:195], a[224:227], a[0:3]
ds_read_b64_tr_b16 a[248:249], v7 offset:50720
v_mfma_f32_16x16x32_bf16 a[0:3], v[196:199], a[228:231], a[0:3]
v_exp_f32 v53, v53
v_mfma_f32_16x16x32_bf16 a[0:3], v[200:203], a[232:235], a[0:3]
ds_read_b64_tr_b16 a[250:251], v7 offset:50976
v_perm_b32 v144, v53, v52, s84
v_mfma_f32_16x16x32_bf16 a[0:3], v[204:207], a[236:239], a[0:3]
v_exp_f32 v54, v54
v_mfma_f32_16x16x32_bf16 a[32:35], v[220:223], a[236:239], a[32:35]
ds_read_b64_tr_b16 a[252:253], v7 offset:51232
v_mfma_f32_16x16x32_bf16 a[32:35], v[216:219], a[232:235], a[32:35]
v_exp_f32 v55, v55
v_mfma_f32_16x16x32_bf16 a[32:35], v[212:215], a[228:231], a[32:35]
ds_read_b64_tr_b16 a[254:255], v7 offset:51488
v_perm_b32 v145, v55, v54, s84
v_mfma_f32_16x16x32_bf16 a[32:35], v[208:211], a[224:227], a[32:35]
s_add_u32 m0, s22, 67584
v_exp_f32 v56, v56
v_mfma_f32_16x16x32_bf16 a[64:67], v[224:227], a[224:227], a[64:67]
buffer_load_dwordx4 v2, s[12:15], s21 offen offset:0 nt lds
v_mfma_f32_16x16x32_bf16 a[64:67], v[228:231], a[228:231], a[64:67]
v_exp_f32 v57, v57
v_mfma_f32_16x16x32_bf16 a[64:67], v[232:235], a[232:235], a[64:67]
v_perm_b32 v160, v57, v56, s84
v_mfma_f32_16x16x32_bf16 a[64:67], v[236:239], a[236:239], a[64:67]
v_exp_f32 v58, v58
v_mfma_f32_16x16x32_bf16 a[96:99], v[252:255], a[236:239], a[96:99]
buffer_load_dwordx4 v3, s[12:15], s21 offen offset:1056 nt lds
v_mfma_f32_16x16x32_bf16 a[96:99], v[248:251], a[232:235], a[96:99]
v_exp_f32 v59, v59
v_mfma_f32_16x16x32_bf16 a[96:99], v[244:247], a[228:231], a[96:99]
s_waitcnt vmcnt(4)
v_perm_b32 v161, v59, v58, s84
v_mfma_f32_16x16x32_bf16 a[96:99], v[240:243], a[224:227], a[96:99]
s_waitcnt lgkmcnt(0)
v_exp_f32 v60, v60
v_mfma_f32_16x16x32_bf16 v[48:51], a[208:211], a[128:131], v[64:67]
ds_read_b128 a[192:195], v6 offset:512
v_mfma_f32_16x16x32_bf16 v[48:51], a[212:215], a[132:135], v[48:51]
v_exp_f32 v61, v61
v_mfma_f32_16x16x32_bf16 v[48:51], a[216:219], a[136:139], v[48:51]
ds_read_b128 a[196:199], v6 offset:576
v_perm_b32 v176, v61, v60, s84
v_mfma_f32_16x16x32_bf16 v[48:51], a[220:223], a[140:143], v[48:51]
v_exp_f32 v62, v62
v_mfma_f32_16x16x32_bf16 v[52:55], a[220:223], a[156:159], v[68:71]
ds_read_b128 a[200:203], v6 offset:640
v_mfma_f32_16x16x32_bf16 v[52:55], a[216:219], a[152:155], v[52:55]
v_exp_f32 v63, v63
v_mfma_f32_16x16x32_bf16 v[52:55], a[212:215], a[148:151], v[52:55]
ds_read_b128 a[204:207], v6 offset:704
v_perm_b32 v177, v63, v62, s84
v_mfma_f32_16x16x32_bf16 v[52:55], a[208:211], a[144:147], v[52:55]
v_exp_f32 v48, v48
v_mfma_f32_16x16x32_bf16 v[56:59], a[208:211], a[160:163], v[72:75]
ds_read_b64_tr_b16 a[224:225], v7 offset:33856
v_mfma_f32_16x16x32_bf16 v[56:59], a[212:215], a[164:167], v[56:59]
v_exp_f32 v49, v49
v_mfma_f32_16x16x32_bf16 v[56:59], a[216:219], a[168:171], v[56:59]
ds_read_b64_tr_b16 a[226:227], v7 offset:34112
v_perm_b32 v130, v49, v48, s84
v_mfma_f32_16x16x32_bf16 v[56:59], a[220:223], a[172:175], v[56:59]
v_exp_f32 v50, v50
v_mfma_f32_16x16x32_bf16 v[60:63], a[220:223], a[188:191], v[76:79]
ds_read_b64_tr_b16 a[228:229], v7 offset:34368
v_mfma_f32_16x16x32_bf16 v[60:63], a[216:219], a[184:187], v[60:63]
v_exp_f32 v51, v51
v_mfma_f32_16x16x32_bf16 v[60:63], a[212:215], a[180:183], v[60:63]
ds_read_b64_tr_b16 a[230:231], v7 offset:34624
v_perm_b32 v131, v51, v50, s84
v_mfma_f32_16x16x32_bf16 v[60:63], a[208:211], a[176:179], v[60:63]
v_exp_f32 v52, v52
v_smfmac_f32_16x16x64_bf16 v[84:87], v[80:83], v[192:199], v45
v_smfmac_f32_16x16x64_bf16 v[84:87], v[80:83], v[200:207], v45
v_mfma_f32_16x16x32_bf16 a[4:7], v[192:195], a[240:243], a[4:7]
ds_read_b64_tr_b16 a[232:233], v7 offset:50752
v_mfma_f32_16x16x32_bf16 a[4:7], v[196:199], a[244:247], a[4:7]
v_exp_f32 v53, v53
v_mfma_f32_16x16x32_bf16 a[4:7], v[200:203], a[248:251], a[4:7]
ds_read_b64_tr_b16 a[234:235], v7 offset:51008
v_perm_b32 v146, v53, v52, s84
v_mfma_f32_16x16x32_bf16 a[4:7], v[204:207], a[252:255], a[4:7]
v_exp_f32 v54, v54
v_mfma_f32_16x16x32_bf16 a[36:39], v[220:223], a[252:255], a[36:39]
ds_read_b64_tr_b16 a[236:237], v7 offset:51264
v_mfma_f32_16x16x32_bf16 a[36:39], v[216:219], a[248:251], a[36:39]
v_exp_f32 v55, v55
v_mfma_f32_16x16x32_bf16 a[36:39], v[212:215], a[244:247], a[36:39]
ds_read_b64_tr_b16 a[238:239], v7 offset:51520
v_perm_b32 v147, v55, v54, s84
v_mfma_f32_16x16x32_bf16 a[36:39], v[208:211], a[240:243], a[36:39]
v_exp_f32 v56, v56
v_mfma_f32_16x16x32_bf16 a[68:71], v[224:227], a[240:243], a[68:71]
buffer_load_dwordx4 v4, s[12:15], s21 offen offset:2112 nt lds
v_mfma_f32_16x16x32_bf16 a[68:71], v[228:231], a[244:247], a[68:71]
v_exp_f32 v57, v57
v_mfma_f32_16x16x32_bf16 a[68:71], v[232:235], a[248:251], a[68:71]
v_perm_b32 v162, v57, v56, s84
v_mfma_f32_16x16x32_bf16 a[68:71], v[236:239], a[252:255], a[68:71]
v_exp_f32 v58, v58
v_mfma_f32_16x16x32_bf16 a[100:103], v[252:255], a[252:255], a[100:103]
buffer_load_dwordx4 v5, s[12:15], s21 offen offset:3168 nt lds
v_mfma_f32_16x16x32_bf16 a[100:103], v[248:251], a[248:251], a[100:103]
s_xor_b32 s21, s21, 8192
v_exp_f32 v59, v59
v_mfma_f32_16x16x32_bf16 a[100:103], v[244:247], a[244:247], a[100:103]
s_waitcnt vmcnt(4)
v_perm_b32 v163, v59, v58, s84
v_mfma_f32_16x16x32_bf16 a[100:103], v[240:243], a[240:243], a[100:103]
s_waitcnt lgkmcnt(0)
v_exp_f32 v60, v60
v_mfma_f32_16x16x32_bf16 v[48:51], a[192:195], a[128:131], v[64:67]
ds_read_b128 a[208:211], v6 offset:768
v_mfma_f32_16x16x32_bf16 v[48:51], a[196:199], a[132:135], v[48:51]
v_exp_f32 v61, v61
v_mfma_f32_16x16x32_bf16 v[48:51], a[200:203], a[136:139], v[48:51]
ds_read_b128 a[212:215], v6 offset:832
v_perm_b32 v178, v61, v60, s84
v_mfma_f32_16x16x32_bf16 v[48:51], a[204:207], a[140:143], v[48:51]
v_exp_f32 v62, v62
v_mfma_f32_16x16x32_bf16 v[52:55], a[204:207], a[156:159], v[68:71]
ds_read_b128 a[216:219], v6 offset:896
v_mfma_f32_16x16x32_bf16 v[52:55], a[200:203], a[152:155], v[52:55]
v_exp_f32 v63, v63
v_mfma_f32_16x16x32_bf16 v[52:55], a[196:199], a[148:151], v[52:55]
ds_read_b128 a[220:223], v6 offset:960
v_perm_b32 v179, v63, v62, s84
v_mfma_f32_16x16x32_bf16 v[52:55], a[192:195], a[144:147], v[52:55]
v_exp_f32 v48, v48
v_mfma_f32_16x16x32_bf16 v[56:59], a[192:195], a[160:163], v[72:75]
ds_read_b64_tr_b16 a[240:241], v7 offset:33888
v_mfma_f32_16x16x32_bf16 v[56:59], a[196:199], a[164:167], v[56:59]
v_exp_f32 v49, v49
v_mfma_f32_16x16x32_bf16 v[56:59], a[200:203], a[168:171], v[56:59]
ds_read_b64_tr_b16 a[242:243], v7 offset:34144
v_perm_b32 v132, v49, v48, s84
v_mfma_f32_16x16x32_bf16 v[56:59], a[204:207], a[172:175], v[56:59]
v_exp_f32 v50, v50
v_mfma_f32_16x16x32_bf16 v[60:63], a[204:207], a[188:191], v[76:79]
ds_read_b64_tr_b16 a[244:245], v7 offset:34400
v_mfma_f32_16x16x32_bf16 v[60:63], a[200:203], a[184:187], v[60:63]
v_exp_f32 v51, v51
v_mfma_f32_16x16x32_bf16 v[60:63], a[196:199], a[180:183], v[60:63]
ds_read_b64_tr_b16 a[246:247], v7 offset:34656
v_perm_b32 v133, v51, v50, s84
v_mfma_f32_16x16x32_bf16 v[60:63], a[192:195], a[176:179], v[60:63]
v_exp_f32 v52, v52
v_mfma_f32_16x16x32_bf16 a[8:11], v[192:195], a[224:227], a[8:11]
ds_read_b64_tr_b16 a[248:249], v7 offset:50784
v_mfma_f32_16x16x32_bf16 a[8:11], v[196:199], a[228:231], a[8:11]
v_exp_f32 v53, v53
v_mfma_f32_16x16x32_bf16 a[8:11], v[200:203], a[232:235], a[8:11]
ds_read_b64_tr_b16 a[250:251], v7 offset:51040
v_perm_b32 v148, v53, v52, s84
v_mfma_f32_16x16x32_bf16 a[8:11], v[204:207], a[236:239], a[8:11]
v_exp_f32 v54, v54
v_mfma_f32_16x16x32_bf16 a[40:43], v[220:223], a[236:239], a[40:43]
ds_read_b64_tr_b16 a[252:253], v7 offset:51296
v_mfma_f32_16x16x32_bf16 a[40:43], v[216:219], a[232:235], a[40:43]
v_exp_f32 v55, v55
v_mfma_f32_16x16x32_bf16 a[40:43], v[212:215], a[228:231], a[40:43]
ds_read_b64_tr_b16 a[254:255], v7 offset:51552
v_perm_b32 v149, v55, v54, s84
v_mfma_f32_16x16x32_bf16 a[40:43], v[208:211], a[224:227], a[40:43]
s_add_u32 m0, s22, 84480
v_exp_f32 v56, v56
v_mfma_f32_16x16x32_bf16 a[72:75], v[224:227], a[224:227], a[72:75]
buffer_load_dwordx4 v2, s[12:15], s21 offen offset:0 nt lds
v_mfma_f32_16x16x32_bf16 a[72:75], v[228:231], a[228:231], a[72:75]
v_exp_f32 v57, v57
v_mfma_f32_16x16x32_bf16 a[72:75], v[232:235], a[232:235], a[72:75]
v_perm_b32 v164, v57, v56, s84
v_mfma_f32_16x16x32_bf16 a[72:75], v[236:239], a[236:239], a[72:75]
v_exp_f32 v58, v58
v_mfma_f32_16x16x32_bf16 a[104:107], v[252:255], a[236:239], a[104:107]
buffer_load_dwordx4 v3, s[12:15], s21 offen offset:1056 nt lds
v_mfma_f32_16x16x32_bf16 a[104:107], v[248:251], a[232:235], a[104:107]
v_exp_f32 v59, v59
v_mfma_f32_16x16x32_bf16 a[104:107], v[244:247], a[228:231], a[104:107]
s_waitcnt vmcnt(4)
v_perm_b32 v165, v59, v58, s84
v_mfma_f32_16x16x32_bf16 a[104:107], v[240:243], a[224:227], a[104:107]
s_waitcnt vmcnt(10) lgkmcnt(0)
v_exp_f32 v60, v60
v_mfma_f32_16x16x32_bf16 v[48:51], a[208:211], a[128:131], v[64:67]
s_barrier
ds_read_b128 a[192:195], v6 offset:16896
v_mfma_f32_16x16x32_bf16 v[48:51], a[212:215], a[132:135], v[48:51]
v_exp_f32 v61, v61
v_mfma_f32_16x16x32_bf16 v[48:51], a[216:219], a[136:139], v[48:51]
ds_read_b128 a[196:199], v6 offset:16960
v_perm_b32 v180, v61, v60, s84
v_mfma_f32_16x16x32_bf16 v[48:51], a[220:223], a[140:143], v[48:51]
v_exp_f32 v62, v62
v_mfma_f32_16x16x32_bf16 v[52:55], a[220:223], a[156:159], v[68:71]
ds_read_b128 a[200:203], v6 offset:17024
v_mfma_f32_16x16x32_bf16 v[52:55], a[216:219], a[152:155], v[52:55]
v_exp_f32 v63, v63
v_mfma_f32_16x16x32_bf16 v[52:55], a[212:215], a[148:151], v[52:55]
ds_read_b128 a[204:207], v6 offset:17088
v_perm_b32 v181, v63, v62, s84
v_mfma_f32_16x16x32_bf16 v[52:55], a[208:211], a[144:147], v[52:55]
v_exp_f32 v48, v48
v_mfma_f32_16x16x32_bf16 v[56:59], a[208:211], a[160:163], v[72:75]
ds_read_b64_tr_b16 a[224:225], v7 offset:33920
v_mfma_f32_16x16x32_bf16 v[56:59], a[212:215], a[164:167], v[56:59]
v_exp_f32 v49, v49
v_mfma_f32_16x16x32_bf16 v[56:59], a[216:219], a[168:171], v[56:59]
ds_read_b64_tr_b16 a[226:227], v7 offset:34176
v_perm_b32 v134, v49, v48, s84
v_mfma_f32_16x16x32_bf16 v[56:59], a[220:223], a[172:175], v[56:59]
v_exp_f32 v50, v50
v_mfma_f32_16x16x32_bf16 v[60:63], a[220:223], a[188:191], v[76:79]
ds_read_b64_tr_b16 a[228:229], v7 offset:34432
v_mfma_f32_16x16x32_bf16 v[60:63], a[216:219], a[184:187], v[60:63]
v_exp_f32 v51, v51
v_mfma_f32_16x16x32_bf16 v[60:63], a[212:215], a[180:183], v[60:63]
ds_read_b64_tr_b16 a[230:231], v7 offset:34688
v_perm_b32 v135, v51, v50, s84
v_mfma_f32_16x16x32_bf16 v[60:63], a[208:211], a[176:179], v[60:63]
v_exp_f32 v52, v52
v_smfmac_f32_16x16x64_bf16 v[88:91], v[80:83], v[208:215], v45
v_smfmac_f32_16x16x64_bf16 v[88:91], v[80:83], v[216:223], v45
v_mfma_f32_16x16x32_bf16 a[12:15], v[192:195], a[240:243], a[12:15]
ds_read_b64_tr_b16 a[232:233], v7 offset:50816
v_mfma_f32_16x16x32_bf16 a[12:15], v[196:199], a[244:247], a[12:15]
v_exp_f32 v53, v53
v_mfma_f32_16x16x32_bf16 a[12:15], v[200:203], a[248:251], a[12:15]
ds_read_b64_tr_b16 a[234:235], v7 offset:51072
v_perm_b32 v150, v53, v52, s84
v_mfma_f32_16x16x32_bf16 a[12:15], v[204:207], a[252:255], a[12:15]
v_exp_f32 v54, v54
v_mfma_f32_16x16x32_bf16 a[44:47], v[220:223], a[252:255], a[44:47]
ds_read_b64_tr_b16 a[236:237], v7 offset:51328
v_mfma_f32_16x16x32_bf16 a[44:47], v[216:219], a[248:251], a[44:47]
v_exp_f32 v55, v55
v_mfma_f32_16x16x32_bf16 a[44:47], v[212:215], a[244:247], a[44:47]
ds_read_b64_tr_b16 a[238:239], v7 offset:51584
v_perm_b32 v151, v55, v54, s84
v_mfma_f32_16x16x32_bf16 a[44:47], v[208:211], a[240:243], a[44:47]
v_exp_f32 v56, v56
v_mfma_f32_16x16x32_bf16 a[76:79], v[224:227], a[240:243], a[76:79]
buffer_load_dwordx4 v4, s[12:15], s21 offen offset:2112 nt lds
v_mfma_f32_16x16x32_bf16 a[76:79], v[228:231], a[244:247], a[76:79]
v_exp_f32 v57, v57
v_mfma_f32_16x16x32_bf16 a[76:79], v[232:235], a[248:251], a[76:79]
v_perm_b32 v166, v57, v56, s84
v_mfma_f32_16x16x32_bf16 a[76:79], v[236:239], a[252:255], a[76:79]
v_exp_f32 v58, v58
v_mfma_f32_16x16x32_bf16 a[108:111], v[252:255], a[252:255], a[108:111]
buffer_load_dwordx4 v5, s[12:15], s21 offen offset:3168 nt lds
v_mfma_f32_16x16x32_bf16 a[108:111], v[248:251], a[248:251], a[108:111]
s_xor_b32 s21, s21, 24576
v_exp_f32 v59, v59
v_mfma_f32_16x16x32_bf16 a[108:111], v[244:247], a[244:247], a[108:111]
s_waitcnt vmcnt(4)
v_perm_b32 v167, v59, v58, s84
v_mfma_f32_16x16x32_bf16 a[108:111], v[240:243], a[240:243], a[108:111]
s_waitcnt lgkmcnt(0)
v_exp_f32 v60, v60
v_mfma_f32_16x16x32_bf16 v[48:51], a[192:195], a[128:131], v[64:67]
ds_read_b128 a[208:211], v6 offset:17152
v_mfma_f32_16x16x32_bf16 v[48:51], a[196:199], a[132:135], v[48:51]
v_exp_f32 v61, v61
v_mfma_f32_16x16x32_bf16 v[48:51], a[200:203], a[136:139], v[48:51]
ds_read_b128 a[212:215], v6 offset:17216
v_perm_b32 v182, v61, v60, s84
v_mfma_f32_16x16x32_bf16 v[48:51], a[204:207], a[140:143], v[48:51]
v_exp_f32 v62, v62
v_mfma_f32_16x16x32_bf16 v[52:55], a[204:207], a[156:159], v[68:71]
ds_read_b128 a[216:219], v6 offset:17280
v_mfma_f32_16x16x32_bf16 v[52:55], a[200:203], a[152:155], v[52:55]
v_exp_f32 v63, v63
v_mfma_f32_16x16x32_bf16 v[52:55], a[196:199], a[148:151], v[52:55]
ds_read_b128 a[220:223], v6 offset:17344
v_perm_b32 v183, v63, v62, s84
v_mfma_f32_16x16x32_bf16 v[52:55], a[192:195], a[144:147], v[52:55]
v_exp_f32 v48, v48
v_mfma_f32_16x16x32_bf16 v[56:59], a[192:195], a[160:163], v[72:75]
ds_read_b64_tr_b16 a[240:241], v7 offset:33952
v_mfma_f32_16x16x32_bf16 v[56:59], a[196:199], a[164:167], v[56:59]
v_exp_f32 v49, v49
v_mfma_f32_16x16x32_bf16 v[56:59], a[200:203], a[168:171], v[56:59]
ds_read_b64_tr_b16 a[242:243], v7 offset:34208
v_perm_b32 v136, v49, v48, s84
v_mfma_f32_16x16x32_bf16 v[56:59], a[204:207], a[172:175], v[56:59]
v_exp_f32 v50, v50
v_mfma_f32_16x16x32_bf16 v[60:63], a[204:207], a[188:191], v[76:79]
ds_read_b64_tr_b16 a[244:245], v7 offset:34464
v_mfma_f32_16x16x32_bf16 v[60:63], a[200:203], a[184:187], v[60:63]
v_exp_f32 v51, v51
v_mfma_f32_16x16x32_bf16 v[60:63], a[196:199], a[180:183], v[60:63]
ds_read_b64_tr_b16 a[246:247], v7 offset:34720
v_perm_b32 v137, v51, v50, s84
v_mfma_f32_16x16x32_bf16 v[60:63], a[192:195], a[176:179], v[60:63]
v_exp_f32 v52, v52
v_mfma_f32_16x16x32_bf16 a[16:19], v[192:195], a[224:227], a[16:19]
ds_read_b64_tr_b16 a[248:249], v7 offset:50848
v_mfma_f32_16x16x32_bf16 a[16:19], v[196:199], a[228:231], a[16:19]
v_exp_f32 v53, v53
v_mfma_f32_16x16x32_bf16 a[16:19], v[200:203], a[232:235], a[16:19]
ds_read_b64_tr_b16 a[250:251], v7 offset:51104
v_perm_b32 v152, v53, v52, s84
v_mfma_f32_16x16x32_bf16 a[16:19], v[204:207], a[236:239], a[16:19]
v_exp_f32 v54, v54
v_mfma_f32_16x16x32_bf16 a[48:51], v[220:223], a[236:239], a[48:51]
ds_read_b64_tr_b16 a[252:253], v7 offset:51360
v_mfma_f32_16x16x32_bf16 a[48:51], v[216:219], a[232:235], a[48:51]
v_exp_f32 v55, v55
v_mfma_f32_16x16x32_bf16 a[48:51], v[212:215], a[228:231], a[48:51]
ds_read_b64_tr_b16 a[254:255], v7 offset:51616
v_perm_b32 v153, v55, v54, s84
v_mfma_f32_16x16x32_bf16 a[48:51], v[208:211], a[224:227], a[48:51]
s_add_u32 m0, s22, 50688
v_exp_f32 v56, v56
v_mfma_f32_16x16x32_bf16 a[80:83], v[224:227], a[224:227], a[80:83]
buffer_load_dwordx4 v2, s[8:11], s20 offen offset:0 nt lds
v_mfma_f32_16x16x32_bf16 a[80:83], v[228:231], a[228:231], a[80:83]
v_exp_f32 v57, v57
v_mfma_f32_16x16x32_bf16 a[80:83], v[232:235], a[232:235], a[80:83]
buffer_load_dwordx4 v3, s[8:11], s20 offen offset:1056 nt lds
v_perm_b32 v168, v57, v56, s84
v_mfma_f32_16x16x32_bf16 a[80:83], v[236:239], a[236:239], a[80:83]
v_exp_f32 v58, v58
v_mfma_f32_16x16x32_bf16 a[112:115], v[252:255], a[236:239], a[112:115]
buffer_load_dwordx4 v4, s[8:11], s20 offen offset:2112 nt lds
v_mfma_f32_16x16x32_bf16 a[112:115], v[248:251], a[232:235], a[112:115]
v_exp_f32 v59, v59
v_mfma_f32_16x16x32_bf16 a[112:115], v[244:247], a[228:231], a[112:115]
v_perm_b32 v169, v59, v58, s84
v_mfma_f32_16x16x32_bf16 a[112:115], v[240:243], a[224:227], a[112:115]
s_waitcnt lgkmcnt(0)
v_exp_f32 v60, v60
v_mfma_f32_16x16x32_bf16 v[48:51], a[208:211], a[128:131], v[64:67]
ds_read_b128 a[192:195], v6 offset:17408
v_mfma_f32_16x16x32_bf16 v[48:51], a[212:215], a[132:135], v[48:51]
v_exp_f32 v61, v61
v_mfma_f32_16x16x32_bf16 v[48:51], a[216:219], a[136:139], v[48:51]
ds_read_b128 a[196:199], v6 offset:17472
v_perm_b32 v184, v61, v60, s84
v_mfma_f32_16x16x32_bf16 v[48:51], a[220:223], a[140:143], v[48:51]
v_exp_f32 v62, v62
v_mfma_f32_16x16x32_bf16 v[52:55], a[220:223], a[156:159], v[68:71]
ds_read_b128 a[200:203], v6 offset:17536
v_mfma_f32_16x16x32_bf16 v[52:55], a[216:219], a[152:155], v[52:55]
v_exp_f32 v63, v63
v_mfma_f32_16x16x32_bf16 v[52:55], a[212:215], a[148:151], v[52:55]
ds_read_b128 a[204:207], v6 offset:17600
v_perm_b32 v185, v63, v62, s84
v_mfma_f32_16x16x32_bf16 v[52:55], a[208:211], a[144:147], v[52:55]
v_exp_f32 v48, v48
v_mfma_f32_16x16x32_bf16 v[56:59], a[208:211], a[160:163], v[72:75]
ds_read_b64_tr_b16 a[224:225], v7 offset:33984
v_mfma_f32_16x16x32_bf16 v[56:59], a[212:215], a[164:167], v[56:59]
v_exp_f32 v49, v49
v_mfma_f32_16x16x32_bf16 v[56:59], a[216:219], a[168:171], v[56:59]
ds_read_b64_tr_b16 a[226:227], v7 offset:34240
v_perm_b32 v138, v49, v48, s84
v_mfma_f32_16x16x32_bf16 v[56:59], a[220:223], a[172:175], v[56:59]
v_exp_f32 v50, v50
v_mfma_f32_16x16x32_bf16 v[60:63], a[220:223], a[188:191], v[76:79]
ds_read_b64_tr_b16 a[228:229], v7 offset:34496
v_mfma_f32_16x16x32_bf16 v[60:63], a[216:219], a[184:187], v[60:63]
v_exp_f32 v51, v51
v_mfma_f32_16x16x32_bf16 v[60:63], a[212:215], a[180:183], v[60:63]
ds_read_b64_tr_b16 a[230:231], v7 offset:34752
v_perm_b32 v139, v51, v50, s84
v_mfma_f32_16x16x32_bf16 v[60:63], a[208:211], a[176:179], v[60:63]
v_exp_f32 v52, v52
v_smfmac_f32_16x16x64_bf16 v[92:95], v[80:83], v[224:231], v45
v_smfmac_f32_16x16x64_bf16 v[92:95], v[80:83], v[232:239], v45
v_mfma_f32_16x16x32_bf16 a[20:23], v[192:195], a[240:243], a[20:23]
ds_read_b64_tr_b16 a[232:233], v7 offset:50880
v_mfma_f32_16x16x32_bf16 a[20:23], v[196:199], a[244:247], a[20:23]
v_exp_f32 v53, v53
v_mfma_f32_16x16x32_bf16 a[20:23], v[200:203], a[248:251], a[20:23]
ds_read_b64_tr_b16 a[234:235], v7 offset:51136
v_perm_b32 v154, v53, v52, s84
v_mfma_f32_16x16x32_bf16 a[20:23], v[204:207], a[252:255], a[20:23]
v_exp_f32 v54, v54
v_mfma_f32_16x16x32_bf16 a[52:55], v[220:223], a[252:255], a[52:55]
ds_read_b64_tr_b16 a[236:237], v7 offset:51392
v_mfma_f32_16x16x32_bf16 a[52:55], v[216:219], a[248:251], a[52:55]
v_exp_f32 v55, v55
v_mfma_f32_16x16x32_bf16 a[52:55], v[212:215], a[244:247], a[52:55]
ds_read_b64_tr_b16 a[238:239], v7 offset:51648
v_perm_b32 v155, v55, v54, s84
v_mfma_f32_16x16x32_bf16 a[52:55], v[208:211], a[240:243], a[52:55]
v_exp_f32 v56, v56
v_mfma_f32_16x16x32_bf16 a[84:87], v[224:227], a[240:243], a[84:87]
buffer_load_dwordx4 v5, s[8:11], s20 offen offset:3168 nt lds
v_mfma_f32_16x16x32_bf16 a[84:87], v[228:231], a[244:247], a[84:87]
s_sub_u32 s95, s95, s96
s_and_b32 s95, s95, s96
s_add_u32 s20, s95, s97
s_add_u32 m0, s22, 0
v_exp_f32 v57, v57
v_mfma_f32_16x16x32_bf16 a[84:87], v[232:235], a[248:251], a[84:87]
buffer_load_dwordx4 v2, s[12:15], s21 offen offset:0 nt lds
v_perm_b32 v170, v57, v56, s84
v_mfma_f32_16x16x32_bf16 a[84:87], v[236:239], a[252:255], a[84:87]
v_exp_f32 v58, v58
v_mfma_f32_16x16x32_bf16 a[116:119], v[252:255], a[252:255], a[116:119]
buffer_load_dwordx4 v3, s[12:15], s21 offen offset:1056 nt lds
v_mfma_f32_16x16x32_bf16 a[116:119], v[248:251], a[248:251], a[116:119]
v_exp_f32 v59, v59
v_mfma_f32_16x16x32_bf16 a[116:119], v[244:247], a[244:247], a[116:119]
v_perm_b32 v171, v59, v58, s84
v_mfma_f32_16x16x32_bf16 a[116:119], v[240:243], a[240:243], a[116:119]
s_waitcnt lgkmcnt(0)
v_exp_f32 v60, v60
v_mfma_f32_16x16x32_bf16 v[48:51], a[192:195], a[128:131], v[64:67]
ds_read_b128 a[208:211], v6 offset:17664
v_mfma_f32_16x16x32_bf16 v[48:51], a[196:199], a[132:135], v[48:51]
v_exp_f32 v61, v61
v_mfma_f32_16x16x32_bf16 v[48:51], a[200:203], a[136:139], v[48:51]
ds_read_b128 a[212:215], v6 offset:17728
v_perm_b32 v186, v61, v60, s84
v_mfma_f32_16x16x32_bf16 v[48:51], a[204:207], a[140:143], v[48:51]
v_exp_f32 v62, v62
v_mfma_f32_16x16x32_bf16 v[52:55], a[204:207], a[156:159], v[68:71]
ds_read_b128 a[216:219], v6 offset:17792
v_mfma_f32_16x16x32_bf16 v[52:55], a[200:203], a[152:155], v[52:55]
v_exp_f32 v63, v63
v_mfma_f32_16x16x32_bf16 v[52:55], a[196:199], a[148:151], v[52:55]
ds_read_b128 a[220:223], v6 offset:17856
v_perm_b32 v187, v63, v62, s84
v_mfma_f32_16x16x32_bf16 v[52:55], a[192:195], a[144:147], v[52:55]
v_exp_f32 v48, v48
v_mfma_f32_16x16x32_bf16 v[56:59], a[192:195], a[160:163], v[72:75]
ds_read_b64_tr_b16 a[240:241], v7 offset:34016
v_mfma_f32_16x16x32_bf16 v[56:59], a[196:199], a[164:167], v[56:59]
v_exp_f32 v49, v49
v_mfma_f32_16x16x32_bf16 v[56:59], a[200:203], a[168:171], v[56:59]
ds_read_b64_tr_b16 a[242:243], v7 offset:34272
v_perm_b32 v140, v49, v48, s84
v_mfma_f32_16x16x32_bf16 v[56:59], a[204:207], a[172:175], v[56:59]
v_exp_f32 v50, v50
v_mfma_f32_16x16x32_bf16 v[60:63], a[204:207], a[188:191], v[76:79]
ds_read_b64_tr_b16 a[244:245], v7 offset:34528
v_mfma_f32_16x16x32_bf16 v[60:63], a[200:203], a[184:187], v[60:63]
v_exp_f32 v51, v51
v_mfma_f32_16x16x32_bf16 v[60:63], a[196:199], a[180:183], v[60:63]
ds_read_b64_tr_b16 a[246:247], v7 offset:34784
v_perm_b32 v141, v51, v50, s84
v_mfma_f32_16x16x32_bf16 v[60:63], a[192:195], a[176:179], v[60:63]
v_exp_f32 v52, v52
v_mfma_f32_16x16x32_bf16 a[24:27], v[192:195], a[224:227], a[24:27]
ds_read_b64_tr_b16 a[248:249], v7 offset:50912
v_mfma_f32_16x16x32_bf16 a[24:27], v[196:199], a[228:231], a[24:27]
v_exp_f32 v53, v53
v_mfma_f32_16x16x32_bf16 a[24:27], v[200:203], a[232:235], a[24:27]
ds_read_b64_tr_b16 a[250:251], v7 offset:51168
v_perm_b32 v156, v53, v52, s84
v_mfma_f32_16x16x32_bf16 a[24:27], v[204:207], a[236:239], a[24:27]
v_exp_f32 v54, v54
v_mfma_f32_16x16x32_bf16 a[56:59], v[220:223], a[236:239], a[56:59]
ds_read_b64_tr_b16 a[252:253], v7 offset:51424
v_mfma_f32_16x16x32_bf16 a[56:59], v[216:219], a[232:235], a[56:59]
v_exp_f32 v55, v55
v_mfma_f32_16x16x32_bf16 a[56:59], v[212:215], a[228:231], a[56:59]
ds_read_b64_tr_b16 a[254:255], v7 offset:51680
v_perm_b32 v157, v55, v54, s84
v_mfma_f32_16x16x32_bf16 a[56:59], v[208:211], a[224:227], a[56:59]
v_exp_f32 v56, v56
v_mfma_f32_16x16x32_bf16 a[88:91], v[224:227], a[224:227], a[88:91]
buffer_load_dwordx4 v4, s[12:15], s21 offen offset:2112 nt lds
v_mfma_f32_16x16x32_bf16 a[88:91], v[228:231], a[228:231], a[88:91]
v_exp_f32 v57, v57
v_mfma_f32_16x16x32_bf16 a[88:91], v[232:235], a[232:235], a[88:91]
v_perm_b32 v172, v57, v56, s84
v_mfma_f32_16x16x32_bf16 a[88:91], v[236:239], a[236:239], a[88:91]
v_exp_f32 v58, v58
v_mfma_f32_16x16x32_bf16 a[120:123], v[252:255], a[236:239], a[120:123]
buffer_load_dwordx4 v5, s[12:15], s21 offen offset:3168 nt lds
v_mfma_f32_16x16x32_bf16 a[120:123], v[248:251], a[232:235], a[120:123]
s_xor_b32 s21, s21, 8192
v_exp_f32 v59, v59
v_mfma_f32_16x16x32_bf16 a[120:123], v[244:247], a[228:231], a[120:123]
v_perm_b32 v173, v59, v58, s84
v_mfma_f32_16x16x32_bf16 a[120:123], v[240:243], a[224:227], a[120:123]
s_waitcnt vmcnt(8) lgkmcnt(0)
v_exp_f32 v60, v60
v_mfma_f32_16x16x32_bf16 v[48:51], a[208:211], a[128:131], v[64:67]
s_barrier
ds_read_b128 a[192:195], v6 offset:33792
v_mfma_f32_16x16x32_bf16 v[48:51], a[212:215], a[132:135], v[48:51]
v_exp_f32 v61, v61
v_mfma_f32_16x16x32_bf16 v[48:51], a[216:219], a[136:139], v[48:51]
ds_read_b128 a[196:199], v6 offset:33856
v_perm_b32 v188, v61, v60, s84
v_mfma_f32_16x16x32_bf16 v[48:51], a[220:223], a[140:143], v[48:51]
v_exp_f32 v62, v62
v_mfma_f32_16x16x32_bf16 v[52:55], a[220:223], a[156:159], v[68:71]
ds_read_b128 a[200:203], v6 offset:33920
v_mfma_f32_16x16x32_bf16 v[52:55], a[216:219], a[152:155], v[52:55]
v_exp_f32 v63, v63
v_mfma_f32_16x16x32_bf16 v[52:55], a[212:215], a[148:151], v[52:55]
ds_read_b128 a[204:207], v6 offset:33984
v_perm_b32 v189, v63, v62, s84
v_mfma_f32_16x16x32_bf16 v[52:55], a[208:211], a[144:147], v[52:55]
v_exp_f32 v48, v48
v_mfma_f32_16x16x32_bf16 v[56:59], a[208:211], a[160:163], v[72:75]
ds_read_b64_tr_b16 a[224:225], v7 offset:0
v_mfma_f32_16x16x32_bf16 v[56:59], a[212:215], a[164:167], v[56:59]
v_exp_f32 v49, v49
v_mfma_f32_16x16x32_bf16 v[56:59], a[216:219], a[168:171], v[56:59]
ds_read_b64_tr_b16 a[226:227], v7 offset:256
v_perm_b32 v142, v49, v48, s84
v_mfma_f32_16x16x32_bf16 v[56:59], a[220:223], a[172:175], v[56:59]
v_exp_f32 v50, v50
v_mfma_f32_16x16x32_bf16 v[60:63], a[220:223], a[188:191], v[76:79]
ds_read_b64_tr_b16 a[228:229], v7 offset:512
v_mfma_f32_16x16x32_bf16 v[60:63], a[216:219], a[184:187], v[60:63]
v_exp_f32 v51, v51
v_mfma_f32_16x16x32_bf16 v[60:63], a[212:215], a[180:183], v[60:63]
ds_read_b64_tr_b16 a[230:231], v7 offset:768
v_perm_b32 v143, v51, v50, s84
v_mfma_f32_16x16x32_bf16 v[60:63], a[208:211], a[176:179], v[60:63]
v_exp_f32 v52, v52
v_smfmac_f32_16x16x64_bf16 v[96:99], v[80:83], v[240:247], v45
v_smfmac_f32_16x16x64_bf16 v[96:99], v[80:83], v[248:255], v45
v_mfma_f32_16x16x32_bf16 a[28:31], v[192:195], a[240:243], a[28:31]
ds_read_b64_tr_b16 a[232:233], v7 offset:16896
v_mfma_f32_16x16x32_bf16 a[28:31], v[196:199], a[244:247], a[28:31]
v_exp_f32 v53, v53
v_mfma_f32_16x16x32_bf16 a[28:31], v[200:203], a[248:251], a[28:31]
ds_read_b64_tr_b16 a[234:235], v7 offset:17152
v_perm_b32 v158, v53, v52, s84
v_mfma_f32_16x16x32_bf16 a[28:31], v[204:207], a[252:255], a[28:31]
v_exp_f32 v54, v54
v_mfma_f32_16x16x32_bf16 a[60:63], v[220:223], a[252:255], a[60:63]
ds_read_b64_tr_b16 a[236:237], v7 offset:17408
v_mfma_f32_16x16x32_bf16 a[60:63], v[216:219], a[248:251], a[60:63]
v_exp_f32 v55, v55
v_mfma_f32_16x16x32_bf16 a[60:63], v[212:215], a[244:247], a[60:63]
ds_read_b64_tr_b16 a[238:239], v7 offset:17664
v_perm_b32 v159, v55, v54, s84
v_mfma_f32_16x16x32_bf16 a[60:63], v[208:211], a[240:243], a[60:63]
s_add_u32 m0, s22, 16896
v_exp_f32 v56, v56
v_mfma_f32_16x16x32_bf16 a[92:95], v[224:227], a[240:243], a[92:95]
buffer_load_dwordx4 v2, s[12:15], s21 offen offset:0 nt lds
v_mfma_f32_16x16x32_bf16 a[92:95], v[228:231], a[244:247], a[92:95]
v_exp_f32 v57, v57
v_mfma_f32_16x16x32_bf16 a[92:95], v[232:235], a[248:251], a[92:95]
buffer_load_dwordx4 v3, s[12:15], s21 offen offset:1056 nt lds
v_perm_b32 v174, v57, v56, s84
v_mfma_f32_16x16x32_bf16 a[92:95], v[236:239], a[252:255], a[92:95]
v_exp_f32 v58, v58
v_mfma_f32_16x16x32_bf16 a[124:127], v[252:255], a[252:255], a[124:127]
buffer_load_dwordx4 v4, s[12:15], s21 offen offset:2112 nt lds
v_mfma_f32_16x16x32_bf16 a[124:127], v[248:251], a[248:251], a[124:127]
v_exp_f32 v59, v59
v_mfma_f32_16x16x32_bf16 a[124:127], v[244:247], a[244:247], a[124:127]
buffer_load_dwordx4 v5, s[12:15], s21 offen offset:3168 nt lds
v_perm_b32 v175, v59, v58, s84
v_mfma_f32_16x16x32_bf16 a[124:127], v[240:243], a[240:243], a[124:127]
s_sub_u32 s94, s94, s96
s_and_b32 s94, s94, s96
s_add_u32 s21, s94, s97
s_waitcnt lgkmcnt(0)
v_exp_f32 v60, v60
v_mfma_f32_16x16x32_bf16 v[48:51], a[192:195], a[128:131], v[64:67]
ds_read_b128 a[208:211], v6 offset:34048
v_mfma_f32_16x16x32_bf16 v[48:51], a[196:199], a[132:135], v[48:51]
v_exp_f32 v61, v61
v_mfma_f32_16x16x32_bf16 v[48:51], a[200:203], a[136:139], v[48:51]
ds_read_b128 a[212:215], v6 offset:34112
v_perm_b32 v190, v61, v60, s84
v_mfma_f32_16x16x32_bf16 v[48:51], a[204:207], a[140:143], v[48:51]
v_exp_f32 v62, v62
v_mfma_f32_16x16x32_bf16 v[52:55], a[204:207], a[156:159], v[68:71]
ds_read_b128 a[216:219], v6 offset:34176
v_mfma_f32_16x16x32_bf16 v[52:55], a[200:203], a[152:155], v[52:55]
v_exp_f32 v63, v63
v_mfma_f32_16x16x32_bf16 v[52:55], a[196:199], a[148:151], v[52:55]
ds_read_b128 a[220:223], v6 offset:34240
v_perm_b32 v191, v63, v62, s84
v_mfma_f32_16x16x32_bf16 v[52:55], a[192:195], a[144:147], v[52:55]
v_exp_f32 v48, v48
v_mfma_f32_16x16x32_bf16 v[56:59], a[192:195], a[160:163], v[72:75]
ds_read_b64_tr_b16 a[240:241], v7 offset:32
v_mfma_f32_16x16x32_bf16 v[56:59], a[196:199], a[164:167], v[56:59]
v_exp_f32 v49, v49
v_mfma_f32_16x16x32_bf16 v[56:59], a[200:203], a[168:171], v[56:59]
ds_read_b64_tr_b16 a[242:243], v7 offset:288
v_perm_b32 v192, v49, v48, s84
v_mfma_f32_16x16x32_bf16 v[56:59], a[204:207], a[172:175], v[56:59]
v_exp_f32 v50, v50
v_mfma_f32_16x16x32_bf16 v[60:63], a[204:207], a[188:191], v[76:79]
ds_read_b64_tr_b16 a[244:245], v7 offset:544
v_mfma_f32_16x16x32_bf16 v[60:63], a[200:203], a[184:187], v[60:63]
v_exp_f32 v51, v51
v_mfma_f32_16x16x32_bf16 v[60:63], a[196:199], a[180:183], v[60:63]
ds_read_b64_tr_b16 a[246:247], v7 offset:800
v_perm_b32 v193, v51, v50, s84
v_mfma_f32_16x16x32_bf16 v[60:63], a[192:195], a[176:179], v[60:63]
v_exp_f32 v52, v52
v_mfma_f32_16x16x32_bf16 a[0:3], v[128:131], a[224:227], a[0:3]
ds_read_b64_tr_b16 a[248:249], v7 offset:16928
v_mfma_f32_16x16x32_bf16 a[0:3], v[132:135], a[228:231], a[0:3]
v_exp_f32 v53, v53
v_mfma_f32_16x16x32_bf16 a[0:3], v[136:139], a[232:235], a[0:3]
ds_read_b64_tr_b16 a[250:251], v7 offset:17184
v_perm_b32 v208, v53, v52, s84
v_mfma_f32_16x16x32_bf16 a[0:3], v[140:143], a[236:239], a[0:3]
v_exp_f32 v54, v54
v_mfma_f32_16x16x32_bf16 a[32:35], v[156:159], a[236:239], a[32:35]
ds_read_b64_tr_b16 a[252:253], v7 offset:17440
v_mfma_f32_16x16x32_bf16 a[32:35], v[152:155], a[232:235], a[32:35]
v_exp_f32 v55, v55
v_mfma_f32_16x16x32_bf16 a[32:35], v[148:151], a[228:231], a[32:35]
ds_read_b64_tr_b16 a[254:255], v7 offset:17696
v_perm_b32 v209, v55, v54, s84
v_mfma_f32_16x16x32_bf16 a[32:35], v[144:147], a[224:227], a[32:35]
v_exp_f32 v56, v56
v_mfma_f32_16x16x32_bf16 a[64:67], v[160:163], a[224:227], a[64:67]
v_mfma_f32_16x16x32_bf16 a[64:67], v[164:167], a[228:231], a[64:67]
v_exp_f32 v57, v57
v_mfma_f32_16x16x32_bf16 a[64:67], v[168:171], a[232:235], a[64:67]
v_perm_b32 v224, v57, v56, s84
v_mfma_f32_16x16x32_bf16 a[64:67], v[172:175], a[236:239], a[64:67]
v_exp_f32 v58, v58
v_mfma_f32_16x16x32_bf16 a[96:99], v[188:191], a[236:239], a[96:99]
v_mfma_f32_16x16x32_bf16 a[96:99], v[184:187], a[232:235], a[96:99]
v_exp_f32 v59, v59
v_mfma_f32_16x16x32_bf16 a[96:99], v[180:183], a[228:231], a[96:99]
v_perm_b32 v225, v59, v58, s84
v_mfma_f32_16x16x32_bf16 a[96:99], v[176:179], a[224:227], a[96:99]
s_waitcnt lgkmcnt(0)
v_exp_f32 v60, v60
v_mfma_f32_16x16x32_bf16 v[48:51], a[208:211], a[128:131], v[64:67]
ds_read_b128 a[192:195], v6 offset:34304
v_mfma_f32_16x16x32_bf16 v[48:51], a[212:215], a[132:135], v[48:51]
v_exp_f32 v61, v61
v_mfma_f32_16x16x32_bf16 v[48:51], a[216:219], a[136:139], v[48:51]
ds_read_b128 a[196:199], v6 offset:34368
v_perm_b32 v240, v61, v60, s84
v_mfma_f32_16x16x32_bf16 v[48:51], a[220:223], a[140:143], v[48:51]
v_exp_f32 v62, v62
v_mfma_f32_16x16x32_bf16 v[52:55], a[220:223], a[156:159], v[68:71]
ds_read_b128 a[200:203], v6 offset:34432
v_mfma_f32_16x16x32_bf16 v[52:55], a[216:219], a[152:155], v[52:55]
v_exp_f32 v63, v63
v_mfma_f32_16x16x32_bf16 v[52:55], a[212:215], a[148:151], v[52:55]
ds_read_b128 a[204:207], v6 offset:34496
v_perm_b32 v241, v63, v62, s84
v_mfma_f32_16x16x32_bf16 v[52:55], a[208:211], a[144:147], v[52:55]
v_exp_f32 v48, v48
v_mfma_f32_16x16x32_bf16 v[56:59], a[208:211], a[160:163], v[72:75]
ds_read_b64_tr_b16 a[224:225], v7 offset:64
v_mfma_f32_16x16x32_bf16 v[56:59], a[212:215], a[164:167], v[56:59]
v_exp_f32 v49, v49
v_mfma_f32_16x16x32_bf16 v[56:59], a[216:219], a[168:171], v[56:59]
ds_read_b64_tr_b16 a[226:227], v7 offset:320
v_perm_b32 v194, v49, v48, s84
v_mfma_f32_16x16x32_bf16 v[56:59], a[220:223], a[172:175], v[56:59]
v_exp_f32 v50, v50
v_mfma_f32_16x16x32_bf16 v[60:63], a[220:223], a[188:191], v[76:79]
ds_read_b64_tr_b16 a[228:229], v7 offset:576
v_mfma_f32_16x16x32_bf16 v[60:63], a[216:219], a[184:187], v[60:63]
v_exp_f32 v51, v51
v_mfma_f32_16x16x32_bf16 v[60:63], a[212:215], a[180:183], v[60:63]
ds_read_b64_tr_b16 a[230:231], v7 offset:832
v_perm_b32 v195, v51, v50, s84
v_mfma_f32_16x16x32_bf16 v[60:63], a[208:211], a[176:179], v[60:63]
v_exp_f32 v52, v52
v_smfmac_f32_16x16x64_bf16 v[84:87], v[80:83], v[128:135], v45
v_smfmac_f32_16x16x64_bf16 v[84:87], v[80:83], v[136:143], v45
v_mfma_f32_16x16x32_bf16 a[4:7], v[128:131], a[240:243], a[4:7]
ds_read_b64_tr_b16 a[232:233], v7 offset:16960
v_mfma_f32_16x16x32_bf16 a[4:7], v[132:135], a[244:247], a[4:7]
v_exp_f32 v53, v53
v_mfma_f32_16x16x32_bf16 a[4:7], v[136:139], a[248:251], a[4:7]
ds_read_b64_tr_b16 a[234:235], v7 offset:17216
v_perm_b32 v210, v53, v52, s84
v_mfma_f32_16x16x32_bf16 a[4:7], v[140:143], a[252:255], a[4:7]
v_exp_f32 v54, v54
v_mfma_f32_16x16x32_bf16 a[36:39], v[156:159], a[252:255], a[36:39]
ds_read_b64_tr_b16 a[236:237], v7 offset:17472
v_mfma_f32_16x16x32_bf16 a[36:39], v[152:155], a[248:251], a[36:39]
v_exp_f32 v55, v55
v_mfma_f32_16x16x32_bf16 a[36:39], v[148:151], a[244:247], a[36:39]
ds_read_b64_tr_b16 a[238:239], v7 offset:17728
v_perm_b32 v211, v55, v54, s84
v_mfma_f32_16x16x32_bf16 a[36:39], v[144:147], a[240:243], a[36:39]
v_exp_f32 v56, v56
v_mfma_f32_16x16x32_bf16 a[68:71], v[160:163], a[240:243], a[68:71]
v_mfma_f32_16x16x32_bf16 a[68:71], v[164:167], a[244:247], a[68:71]
v_exp_f32 v57, v57
v_mfma_f32_16x16x32_bf16 a[68:71], v[168:171], a[248:251], a[68:71]
v_perm_b32 v226, v57, v56, s84
v_mfma_f32_16x16x32_bf16 a[68:71], v[172:175], a[252:255], a[68:71]
v_exp_f32 v58, v58
v_mfma_f32_16x16x32_bf16 a[100:103], v[188:191], a[252:255], a[100:103]
v_mfma_f32_16x16x32_bf16 a[100:103], v[184:187], a[248:251], a[100:103]
v_exp_f32 v59, v59
v_mfma_f32_16x16x32_bf16 a[100:103], v[180:183], a[244:247], a[100:103]
v_perm_b32 v227, v59, v58, s84
v_mfma_f32_16x16x32_bf16 a[100:103], v[176:179], a[240:243], a[100:103]
s_waitcnt lgkmcnt(0)
v_exp_f32 v60, v60
v_mfma_f32_16x16x32_bf16 v[48:51], a[192:195], a[128:131], v[64:67]
ds_read_b128 a[208:211], v6 offset:34560
v_mfma_f32_16x16x32_bf16 v[48:51], a[196:199], a[132:135], v[48:51]
v_exp_f32 v61, v61
v_mfma_f32_16x16x32_bf16 v[48:51], a[200:203], a[136:139], v[48:51]
ds_read_b128 a[212:215], v6 offset:34624
v_perm_b32 v242, v61, v60, s84
v_mfma_f32_16x16x32_bf16 v[48:51], a[204:207], a[140:143], v[48:51]
v_exp_f32 v62, v62
v_mfma_f32_16x16x32_bf16 v[52:55], a[204:207], a[156:159], v[68:71]
ds_read_b128 a[216:219], v6 offset:34688
v_mfma_f32_16x16x32_bf16 v[52:55], a[200:203], a[152:155], v[52:55]
v_exp_f32 v63, v63
v_mfma_f32_16x16x32_bf16 v[52:55], a[196:199], a[148:151], v[52:55]
ds_read_b128 a[220:223], v6 offset:34752
v_perm_b32 v243, v63, v62, s84
v_mfma_f32_16x16x32_bf16 v[52:55], a[192:195], a[144:147], v[52:55]
v_exp_f32 v48, v48
v_mfma_f32_16x16x32_bf16 v[56:59], a[192:195], a[160:163], v[72:75]
ds_read_b64_tr_b16 a[240:241], v7 offset:96
v_mfma_f32_16x16x32_bf16 v[56:59], a[196:199], a[164:167], v[56:59]
v_exp_f32 v49, v49
v_mfma_f32_16x16x32_bf16 v[56:59], a[200:203], a[168:171], v[56:59]
ds_read_b64_tr_b16 a[242:243], v7 offset:352
v_perm_b32 v196, v49, v48, s84
v_mfma_f32_16x16x32_bf16 v[56:59], a[204:207], a[172:175], v[56:59]
v_exp_f32 v50, v50
v_mfma_f32_16x16x32_bf16 v[60:63], a[204:207], a[188:191], v[76:79]
ds_read_b64_tr_b16 a[244:245], v7 offset:608
v_mfma_f32_16x16x32_bf16 v[60:63], a[200:203], a[184:187], v[60:63]
v_exp_f32 v51, v51
v_mfma_f32_16x16x32_bf16 v[60:63], a[196:199], a[180:183], v[60:63]
ds_read_b64_tr_b16 a[246:247], v7 offset:864
v_perm_b32 v197, v51, v50, s84
v_mfma_f32_16x16x32_bf16 v[60:63], a[192:195], a[176:179], v[60:63]
v_exp_f32 v52, v52
v_mfma_f32_16x16x32_bf16 a[8:11], v[128:131], a[224:227], a[8:11]
ds_read_b64_tr_b16 a[248:249], v7 offset:16992
v_mfma_f32_16x16x32_bf16 a[8:11], v[132:135], a[228:231], a[8:11]
v_exp_f32 v53, v53
v_mfma_f32_16x16x32_bf16 a[8:11], v[136:139], a[232:235], a[8:11]
ds_read_b64_tr_b16 a[250:251], v7 offset:17248
v_perm_b32 v212, v53, v52, s84
v_mfma_f32_16x16x32_bf16 a[8:11], v[140:143], a[236:239], a[8:11]
v_exp_f32 v54, v54
v_mfma_f32_16x16x32_bf16 a[40:43], v[156:159], a[236:239], a[40:43]
ds_read_b64_tr_b16 a[252:253], v7 offset:17504
v_mfma_f32_16x16x32_bf16 a[40:43], v[152:155], a[232:235], a[40:43]
v_exp_f32 v55, v55
v_mfma_f32_16x16x32_bf16 a[40:43], v[148:151], a[228:231], a[40:43]
ds_read_b64_tr_b16 a[254:255], v7 offset:17760
v_perm_b32 v213, v55, v54, s84
v_mfma_f32_16x16x32_bf16 a[40:43], v[144:147], a[224:227], a[40:43]
v_exp_f32 v56, v56
v_mfma_f32_16x16x32_bf16 a[72:75], v[160:163], a[224:227], a[72:75]
v_mfma_f32_16x16x32_bf16 a[72:75], v[164:167], a[228:231], a[72:75]
v_exp_f32 v57, v57
v_mfma_f32_16x16x32_bf16 a[72:75], v[168:171], a[232:235], a[72:75]
v_perm_b32 v228, v57, v56, s84
v_mfma_f32_16x16x32_bf16 a[72:75], v[172:175], a[236:239], a[72:75]
v_exp_f32 v58, v58
v_mfma_f32_16x16x32_bf16 a[104:107], v[188:191], a[236:239], a[104:107]
v_mfma_f32_16x16x32_bf16 a[104:107], v[184:187], a[232:235], a[104:107]
v_exp_f32 v59, v59
v_mfma_f32_16x16x32_bf16 a[104:107], v[180:183], a[228:231], a[104:107]
v_perm_b32 v229, v59, v58, s84
v_mfma_f32_16x16x32_bf16 a[104:107], v[176:179], a[224:227], a[104:107]
s_waitcnt vmcnt(8) lgkmcnt(0)
v_exp_f32 v60, v60
v_mfma_f32_16x16x32_bf16 v[48:51], a[208:211], a[128:131], v[64:67]
s_barrier
ds_read_b128 a[192:195], v6 offset:50688
v_mfma_f32_16x16x32_bf16 v[48:51], a[212:215], a[132:135], v[48:51]
v_exp_f32 v61, v61
v_mfma_f32_16x16x32_bf16 v[48:51], a[216:219], a[136:139], v[48:51]
ds_read_b128 a[196:199], v6 offset:50752
v_perm_b32 v244, v61, v60, s84
v_mfma_f32_16x16x32_bf16 v[48:51], a[220:223], a[140:143], v[48:51]
v_exp_f32 v62, v62
v_mfma_f32_16x16x32_bf16 v[52:55], a[220:223], a[156:159], v[68:71]
ds_read_b128 a[200:203], v6 offset:50816
v_mfma_f32_16x16x32_bf16 v[52:55], a[216:219], a[152:155], v[52:55]
v_exp_f32 v63, v63
v_mfma_f32_16x16x32_bf16 v[52:55], a[212:215], a[148:151], v[52:55]
ds_read_b128 a[204:207], v6 offset:50880
v_perm_b32 v245, v63, v62, s84
v_mfma_f32_16x16x32_bf16 v[52:55], a[208:211], a[144:147], v[52:55]
v_exp_f32 v48, v48
v_mfma_f32_16x16x32_bf16 v[56:59], a[208:211], a[160:163], v[72:75]
ds_read_b64_tr_b16 a[224:225], v7 offset:128
v_mfma_f32_16x16x32_bf16 v[56:59], a[212:215], a[164:167], v[56:59]
v_exp_f32 v49, v49
v_mfma_f32_16x16x32_bf16 v[56:59], a[216:219], a[168:171], v[56:59]
ds_read_b64_tr_b16 a[226:227], v7 offset:384
v_perm_b32 v198, v49, v48, s84
v_mfma_f32_16x16x32_bf16 v[56:59], a[220:223], a[172:175], v[56:59]
v_exp_f32 v50, v50
v_mfma_f32_16x16x32_bf16 v[60:63], a[220:223], a[188:191], v[76:79]
ds_read_b64_tr_b16 a[228:229], v7 offset:640
v_mfma_f32_16x16x32_bf16 v[60:63], a[216:219], a[184:187], v[60:63]
v_exp_f32 v51, v51
v_mfma_f32_16x16x32_bf16 v[60:63], a[212:215], a[180:183], v[60:63]
ds_read_b64_tr_b16 a[230:231], v7 offset:896
v_perm_b32 v199, v51, v50, s84
v_mfma_f32_16x16x32_bf16 v[60:63], a[208:211], a[176:179], v[60:63]
v_exp_f32 v52, v52
v_smfmac_f32_16x16x64_bf16 v[88:91], v[80:83], v[144:151], v45
v_smfmac_f32_16x16x64_bf16 v[88:91], v[80:83], v[152:159], v45
v_mfma_f32_16x16x32_bf16 a[12:15], v[128:131], a[240:243], a[12:15]
ds_read_b64_tr_b16 a[232:233], v7 offset:17024
v_mfma_f32_16x16x32_bf16 a[12:15], v[132:135], a[244:247], a[12:15]
v_exp_f32 v53, v53
v_mfma_f32_16x16x32_bf16 a[12:15], v[136:139], a[248:251], a[12:15]
ds_read_b64_tr_b16 a[234:235], v7 offset:17280
v_perm_b32 v214, v53, v52, s84
v_mfma_f32_16x16x32_bf16 a[12:15], v[140:143], a[252:255], a[12:15]
v_exp_f32 v54, v54
v_mfma_f32_16x16x32_bf16 a[44:47], v[156:159], a[252:255], a[44:47]
ds_read_b64_tr_b16 a[236:237], v7 offset:17536
v_mfma_f32_16x16x32_bf16 a[44:47], v[152:155], a[248:251], a[44:47]
v_exp_f32 v55, v55
v_mfma_f32_16x16x32_bf16 a[44:47], v[148:151], a[244:247], a[44:47]
ds_read_b64_tr_b16 a[238:239], v7 offset:17792
v_perm_b32 v215, v55, v54, s84
v_mfma_f32_16x16x32_bf16 a[44:47], v[144:147], a[240:243], a[44:47]
v_exp_f32 v56, v56
v_mfma_f32_16x16x32_bf16 a[76:79], v[160:163], a[240:243], a[76:79]
v_mfma_f32_16x16x32_bf16 a[76:79], v[164:167], a[244:247], a[76:79]
v_exp_f32 v57, v57
v_mfma_f32_16x16x32_bf16 a[76:79], v[168:171], a[248:251], a[76:79]
v_perm_b32 v230, v57, v56, s84
v_mfma_f32_16x16x32_bf16 a[76:79], v[172:175], a[252:255], a[76:79]
v_exp_f32 v58, v58
v_mfma_f32_16x16x32_bf16 a[108:111], v[188:191], a[252:255], a[108:111]
v_mfma_f32_16x16x32_bf16 a[108:111], v[184:187], a[248:251], a[108:111]
v_exp_f32 v59, v59
v_mfma_f32_16x16x32_bf16 a[108:111], v[180:183], a[244:247], a[108:111]
v_perm_b32 v231, v59, v58, s84
v_mfma_f32_16x16x32_bf16 a[108:111], v[176:179], a[240:243], a[108:111]
s_waitcnt lgkmcnt(0)
v_exp_f32 v60, v60
v_mfma_f32_16x16x32_bf16 v[48:51], a[192:195], a[128:131], v[64:67]
ds_read_b128 a[208:211], v6 offset:50944
v_mfma_f32_16x16x32_bf16 v[48:51], a[196:199], a[132:135], v[48:51]
v_exp_f32 v61, v61
v_mfma_f32_16x16x32_bf16 v[48:51], a[200:203], a[136:139], v[48:51]
ds_read_b128 a[212:215], v6 offset:51008
v_perm_b32 v246, v61, v60, s84
v_mfma_f32_16x16x32_bf16 v[48:51], a[204:207], a[140:143], v[48:51]
v_exp_f32 v62, v62
v_mfma_f32_16x16x32_bf16 v[52:55], a[204:207], a[156:159], v[68:71]
ds_read_b128 a[216:219], v6 offset:51072
v_mfma_f32_16x16x32_bf16 v[52:55], a[200:203], a[152:155], v[52:55]
v_exp_f32 v63, v63
v_mfma_f32_16x16x32_bf16 v[52:55], a[196:199], a[148:151], v[52:55]
ds_read_b128 a[220:223], v6 offset:51136
v_perm_b32 v247, v63, v62, s84
v_mfma_f32_16x16x32_bf16 v[52:55], a[192:195], a[144:147], v[52:55]
v_exp_f32 v48, v48
v_mfma_f32_16x16x32_bf16 v[56:59], a[192:195], a[160:163], v[72:75]
ds_read_b64_tr_b16 a[240:241], v7 offset:160
v_mfma_f32_16x16x32_bf16 v[56:59], a[196:199], a[164:167], v[56:59]
v_exp_f32 v49, v49
v_mfma_f32_16x16x32_bf16 v[56:59], a[200:203], a[168:171], v[56:59]
ds_read_b64_tr_b16 a[242:243], v7 offset:416
v_perm_b32 v200, v49, v48, s84
v_mfma_f32_16x16x32_bf16 v[56:59], a[204:207], a[172:175], v[56:59]
v_exp_f32 v50, v50
v_mfma_f32_16x16x32_bf16 v[60:63], a[204:207], a[188:191], v[76:79]
ds_read_b64_tr_b16 a[244:245], v7 offset:672
v_mfma_f32_16x16x32_bf16 v[60:63], a[200:203], a[184:187], v[60:63]
v_exp_f32 v51, v51
v_mfma_f32_16x16x32_bf16 v[60:63], a[196:199], a[180:183], v[60:63]
ds_read_b64_tr_b16 a[246:247], v7 offset:928
v_perm_b32 v201, v51, v50, s84
v_mfma_f32_16x16x32_bf16 v[60:63], a[192:195], a[176:179], v[60:63]
v_exp_f32 v52, v52
v_mfma_f32_16x16x32_bf16 a[16:19], v[128:131], a[224:227], a[16:19]
ds_read_b64_tr_b16 a[248:249], v7 offset:17056
v_mfma_f32_16x16x32_bf16 a[16:19], v[132:135], a[228:231], a[16:19]
v_exp_f32 v53, v53
v_mfma_f32_16x16x32_bf16 a[16:19], v[136:139], a[232:235], a[16:19]
ds_read_b64_tr_b16 a[250:251], v7 offset:17312
v_perm_b32 v216, v53, v52, s84
v_mfma_f32_16x16x32_bf16 a[16:19], v[140:143], a[236:239], a[16:19]
v_exp_f32 v54, v54
v_mfma_f32_16x16x32_bf16 a[48:51], v[156:159], a[236:239], a[48:51]
ds_read_b64_tr_b16 a[252:253], v7 offset:17568
v_mfma_f32_16x16x32_bf16 a[48:51], v[152:155], a[232:235], a[48:51]
v_exp_f32 v55, v55
v_mfma_f32_16x16x32_bf16 a[48:51], v[148:151], a[228:231], a[48:51]
ds_read_b64_tr_b16 a[254:255], v7 offset:17824
v_perm_b32 v217, v55, v54, s84
v_mfma_f32_16x16x32_bf16 a[48:51], v[144:147], a[224:227], a[48:51]
v_exp_f32 v56, v56
v_mfma_f32_16x16x32_bf16 a[80:83], v[160:163], a[224:227], a[80:83]
v_mfma_f32_16x16x32_bf16 a[80:83], v[164:167], a[228:231], a[80:83]
v_exp_f32 v57, v57
v_mfma_f32_16x16x32_bf16 a[80:83], v[168:171], a[232:235], a[80:83]
v_perm_b32 v232, v57, v56, s84
v_mfma_f32_16x16x32_bf16 a[80:83], v[172:175], a[236:239], a[80:83]
v_exp_f32 v58, v58
v_mfma_f32_16x16x32_bf16 a[112:115], v[188:191], a[236:239], a[112:115]
v_mfma_f32_16x16x32_bf16 a[112:115], v[184:187], a[232:235], a[112:115]
v_exp_f32 v59, v59
v_mfma_f32_16x16x32_bf16 a[112:115], v[180:183], a[228:231], a[112:115]
v_perm_b32 v233, v59, v58, s84
v_mfma_f32_16x16x32_bf16 a[112:115], v[176:179], a[224:227], a[112:115]
s_waitcnt lgkmcnt(0)
v_exp_f32 v60, v60
v_mfma_f32_16x16x32_bf16 v[48:51], a[208:211], a[128:131], v[64:67]
ds_read_b128 a[192:195], v6 offset:51200
v_mfma_f32_16x16x32_bf16 v[48:51], a[212:215], a[132:135], v[48:51]
v_exp_f32 v61, v61
v_mfma_f32_16x16x32_bf16 v[48:51], a[216:219], a[136:139], v[48:51]
ds_read_b128 a[196:199], v6 offset:51264
v_perm_b32 v248, v61, v60, s84
v_mfma_f32_16x16x32_bf16 v[48:51], a[220:223], a[140:143], v[48:51]
v_exp_f32 v62, v62
v_mfma_f32_16x16x32_bf16 v[52:55], a[220:223], a[156:159], v[68:71]
ds_read_b128 a[200:203], v6 offset:51328
v_mfma_f32_16x16x32_bf16 v[52:55], a[216:219], a[152:155], v[52:55]
v_exp_f32 v63, v63
v_mfma_f32_16x16x32_bf16 v[52:55], a[212:215], a[148:151], v[52:55]
ds_read_b128 a[204:207], v6 offset:51392
v_perm_b32 v249, v63, v62, s84
v_mfma_f32_16x16x32_bf16 v[52:55], a[208:211], a[144:147], v[52:55]
v_exp_f32 v48, v48
v_mfma_f32_16x16x32_bf16 v[56:59], a[208:211], a[160:163], v[72:75]
ds_read_b64_tr_b16 a[224:225], v7 offset:192
v_mfma_f32_16x16x32_bf16 v[56:59], a[212:215], a[164:167], v[56:59]
v_exp_f32 v49, v49
v_mfma_f32_16x16x32_bf16 v[56:59], a[216:219], a[168:171], v[56:59]
ds_read_b64_tr_b16 a[226:227], v7 offset:448
v_perm_b32 v202, v49, v48, s84
v_mfma_f32_16x16x32_bf16 v[56:59], a[220:223], a[172:175], v[56:59]
v_exp_f32 v50, v50
v_mfma_f32_16x16x32_bf16 v[60:63], a[220:223], a[188:191], v[76:79]
ds_read_b64_tr_b16 a[228:229], v7 offset:704
v_mfma_f32_16x16x32_bf16 v[60:63], a[216:219], a[184:187], v[60:63]
v_exp_f32 v51, v51
v_mfma_f32_16x16x32_bf16 v[60:63], a[212:215], a[180:183], v[60:63]
ds_read_b64_tr_b16 a[230:231], v7 offset:960
v_perm_b32 v203, v51, v50, s84
v_mfma_f32_16x16x32_bf16 v[60:63], a[208:211], a[176:179], v[60:63]
v_exp_f32 v52, v52
v_smfmac_f32_16x16x64_bf16 v[92:95], v[80:83], v[160:167], v45
v_smfmac_f32_16x16x64_bf16 v[92:95], v[80:83], v[168:175], v45
v_mfma_f32_16x16x32_bf16 a[20:23], v[128:131], a[240:243], a[20:23]
ds_read_b64_tr_b16 a[232:233], v7 offset:17088
v_mfma_f32_16x16x32_bf16 a[20:23], v[132:135], a[244:247], a[20:23]
v_exp_f32 v53, v53
v_mfma_f32_16x16x32_bf16 a[20:23], v[136:139], a[248:251], a[20:23]
ds_read_b64_tr_b16 a[234:235], v7 offset:17344
v_perm_b32 v218, v53, v52, s84
v_mfma_f32_16x16x32_bf16 a[20:23], v[140:143], a[252:255], a[20:23]
v_exp_f32 v54, v54
v_mfma_f32_16x16x32_bf16 a[52:55], v[156:159], a[252:255], a[52:55]
ds_read_b64_tr_b16 a[236:237], v7 offset:17600
v_mfma_f32_16x16x32_bf16 a[52:55], v[152:155], a[248:251], a[52:55]
v_exp_f32 v55, v55
v_mfma_f32_16x16x32_bf16 a[52:55], v[148:151], a[244:247], a[52:55]
ds_read_b64_tr_b16 a[238:239], v7 offset:17856
v_perm_b32 v219, v55, v54, s84
v_mfma_f32_16x16x32_bf16 a[52:55], v[144:147], a[240:243], a[52:55]
v_exp_f32 v56, v56
v_mfma_f32_16x16x32_bf16 a[84:87], v[160:163], a[240:243], a[84:87]
v_mfma_f32_16x16x32_bf16 a[84:87], v[164:167], a[244:247], a[84:87]
v_exp_f32 v57, v57
v_mfma_f32_16x16x32_bf16 a[84:87], v[168:171], a[248:251], a[84:87]
v_perm_b32 v234, v57, v56, s84
v_mfma_f32_16x16x32_bf16 a[84:87], v[172:175], a[252:255], a[84:87]
v_exp_f32 v58, v58
v_mfma_f32_16x16x32_bf16 a[116:119], v[188:191], a[252:255], a[116:119]
v_mfma_f32_16x16x32_bf16 a[116:119], v[184:187], a[248:251], a[116:119]
v_exp_f32 v59, v59
v_mfma_f32_16x16x32_bf16 a[116:119], v[180:183], a[244:247], a[116:119]
v_perm_b32 v235, v59, v58, s84
v_mfma_f32_16x16x32_bf16 a[116:119], v[176:179], a[240:243], a[116:119]
s_waitcnt lgkmcnt(0)
v_exp_f32 v60, v60
v_mfma_f32_16x16x32_bf16 v[48:51], a[192:195], a[128:131], v[64:67]
ds_read_b128 a[208:211], v6 offset:51456
v_mfma_f32_16x16x32_bf16 v[48:51], a[196:199], a[132:135], v[48:51]
v_exp_f32 v61, v61
v_mfma_f32_16x16x32_bf16 v[48:51], a[200:203], a[136:139], v[48:51]
ds_read_b128 a[212:215], v6 offset:51520
v_perm_b32 v250, v61, v60, s84
v_mfma_f32_16x16x32_bf16 v[48:51], a[204:207], a[140:143], v[48:51]
v_exp_f32 v62, v62
v_mfma_f32_16x16x32_bf16 v[52:55], a[204:207], a[156:159], v[68:71]
ds_read_b128 a[216:219], v6 offset:51584
v_mfma_f32_16x16x32_bf16 v[52:55], a[200:203], a[152:155], v[52:55]
v_exp_f32 v63, v63
v_mfma_f32_16x16x32_bf16 v[52:55], a[196:199], a[148:151], v[52:55]
ds_read_b128 a[220:223], v6 offset:51648
v_perm_b32 v251, v63, v62, s84
v_mfma_f32_16x16x32_bf16 v[52:55], a[192:195], a[144:147], v[52:55]
v_exp_f32 v48, v48
v_mfma_f32_16x16x32_bf16 v[56:59], a[192:195], a[160:163], v[72:75]
ds_read_b64_tr_b16 a[240:241], v7 offset:224
v_mfma_f32_16x16x32_bf16 v[56:59], a[196:199], a[164:167], v[56:59]
v_exp_f32 v49, v49
v_mfma_f32_16x16x32_bf16 v[56:59], a[200:203], a[168:171], v[56:59]
ds_read_b64_tr_b16 a[242:243], v7 offset:480
v_perm_b32 v204, v49, v48, s84
v_mfma_f32_16x16x32_bf16 v[56:59], a[204:207], a[172:175], v[56:59]
v_exp_f32 v50, v50
v_mfma_f32_16x16x32_bf16 v[60:63], a[204:207], a[188:191], v[76:79]
ds_read_b64_tr_b16 a[244:245], v7 offset:736
v_mfma_f32_16x16x32_bf16 v[60:63], a[200:203], a[184:187], v[60:63]
v_exp_f32 v51, v51
v_mfma_f32_16x16x32_bf16 v[60:63], a[196:199], a[180:183], v[60:63]
ds_read_b64_tr_b16 a[246:247], v7 offset:992
v_perm_b32 v205, v51, v50, s84
v_mfma_f32_16x16x32_bf16 v[60:63], a[192:195], a[176:179], v[60:63]
v_exp_f32 v52, v52
v_mfma_f32_16x16x32_bf16 a[24:27], v[128:131], a[224:227], a[24:27]
ds_read_b64_tr_b16 a[248:249], v7 offset:17120
v_mfma_f32_16x16x32_bf16 a[24:27], v[132:135], a[228:231], a[24:27]
v_exp_f32 v53, v53
v_mfma_f32_16x16x32_bf16 a[24:27], v[136:139], a[232:235], a[24:27]
ds_read_b64_tr_b16 a[250:251], v7 offset:17376
v_perm_b32 v220, v53, v52, s84
v_mfma_f32_16x16x32_bf16 a[24:27], v[140:143], a[236:239], a[24:27]
v_exp_f32 v54, v54
v_mfma_f32_16x16x32_bf16 a[56:59], v[156:159], a[236:239], a[56:59]
ds_read_b64_tr_b16 a[252:253], v7 offset:17632
v_mfma_f32_16x16x32_bf16 a[56:59], v[152:155], a[232:235], a[56:59]
v_exp_f32 v55, v55
v_mfma_f32_16x16x32_bf16 a[56:59], v[148:151], a[228:231], a[56:59]
ds_read_b64_tr_b16 a[254:255], v7 offset:17888
v_perm_b32 v221, v55, v54, s84
v_mfma_f32_16x16x32_bf16 a[56:59], v[144:147], a[224:227], a[56:59]
v_exp_f32 v56, v56
v_mfma_f32_16x16x32_bf16 a[88:91], v[160:163], a[224:227], a[88:91]
v_mfma_f32_16x16x32_bf16 a[88:91], v[164:167], a[228:231], a[88:91]
v_exp_f32 v57, v57
v_mfma_f32_16x16x32_bf16 a[88:91], v[168:171], a[232:235], a[88:91]
v_perm_b32 v236, v57, v56, s84
v_mfma_f32_16x16x32_bf16 a[88:91], v[172:175], a[236:239], a[88:91]
v_exp_f32 v58, v58
v_mfma_f32_16x16x32_bf16 a[120:123], v[188:191], a[236:239], a[120:123]
v_mfma_f32_16x16x32_bf16 a[120:123], v[184:187], a[232:235], a[120:123]
v_exp_f32 v59, v59
v_mfma_f32_16x16x32_bf16 a[120:123], v[180:183], a[228:231], a[120:123]
v_perm_b32 v237, v59, v58, s84
v_mfma_f32_16x16x32_bf16 a[120:123], v[176:179], a[224:227], a[120:123]
s_waitcnt vmcnt(0) lgkmcnt(0)
v_exp_f32 v60, v60
v_mfma_f32_16x16x32_bf16 v[48:51], a[208:211], a[128:131], v[64:67]
s_barrier
v_mfma_f32_16x16x32_bf16 v[48:51], a[212:215], a[132:135], v[48:51]
v_exp_f32 v61, v61
v_mfma_f32_16x16x32_bf16 v[48:51], a[216:219], a[136:139], v[48:51]
v_perm_b32 v252, v61, v60, s84
v_mfma_f32_16x16x32_bf16 v[48:51], a[220:223], a[140:143], v[48:51]
v_exp_f32 v62, v62
v_mfma_f32_16x16x32_bf16 v[52:55], a[220:223], a[156:159], v[68:71]
v_mfma_f32_16x16x32_bf16 v[52:55], a[216:219], a[152:155], v[52:55]
v_exp_f32 v63, v63
v_mfma_f32_16x16x32_bf16 v[52:55], a[212:215], a[148:151], v[52:55]
v_perm_b32 v253, v63, v62, s84
v_mfma_f32_16x16x32_bf16 v[52:55], a[208:211], a[144:147], v[52:55]
s_nop 0
v_exp_f32 v48, v48
v_mfma_f32_16x16x32_bf16 v[56:59], a[208:211], a[160:163], v[72:75]
ds_read_b64_tr_b16 a[224:225], v33 offset:0
v_mfma_f32_16x16x32_bf16 v[56:59], a[212:215], a[164:167], v[56:59]
v_exp_f32 v49, v49
v_mfma_f32_16x16x32_bf16 v[56:59], a[216:219], a[168:171], v[56:59]
ds_read_b64_tr_b16 a[226:227], v33 offset:256
v_perm_b32 v206, v49, v48, s84
v_mfma_f32_16x16x32_bf16 v[56:59], a[220:223], a[172:175], v[56:59]
v_exp_f32 v50, v50
v_mfma_f32_16x16x32_bf16 v[60:63], a[220:223], a[188:191], v[76:79]
ds_read_b64_tr_b16 a[228:229], v33 offset:512
v_mfma_f32_16x16x32_bf16 v[60:63], a[216:219], a[184:187], v[60:63]
v_exp_f32 v51, v51
v_mfma_f32_16x16x32_bf16 v[60:63], a[212:215], a[180:183], v[60:63]
ds_read_b64_tr_b16 a[230:231], v33 offset:768
v_perm_b32 v207, v51, v50, s84
v_mfma_f32_16x16x32_bf16 v[60:63], a[208:211], a[176:179], v[60:63]
v_exp_f32 v52, v52
v_smfmac_f32_16x16x64_bf16 v[96:99], v[80:83], v[176:183], v45
v_smfmac_f32_16x16x64_bf16 v[96:99], v[80:83], v[184:191], v45
v_mfma_f32_16x16x32_bf16 a[28:31], v[128:131], a[240:243], a[28:31]
ds_read_b64_tr_b16 a[232:233], v33 offset:16896
v_mfma_f32_16x16x32_bf16 a[28:31], v[132:135], a[244:247], a[28:31]
v_exp_f32 v53, v53
v_mfma_f32_16x16x32_bf16 a[28:31], v[136:139], a[248:251], a[28:31]
ds_read_b64_tr_b16 a[234:235], v33 offset:17152
v_perm_b32 v222, v53, v52, s84
v_mfma_f32_16x16x32_bf16 a[28:31], v[140:143], a[252:255], a[28:31]
v_exp_f32 v54, v54
v_mfma_f32_16x16x32_bf16 a[60:63], v[156:159], a[252:255], a[60:63]
ds_read_b64_tr_b16 a[236:237], v33 offset:17408
v_mfma_f32_16x16x32_bf16 a[60:63], v[152:155], a[248:251], a[60:63]
v_exp_f32 v55, v55
v_mfma_f32_16x16x32_bf16 a[60:63], v[148:151], a[244:247], a[60:63]
ds_read_b64_tr_b16 a[238:239], v33 offset:17664
v_perm_b32 v223, v55, v54, s84
v_mfma_f32_16x16x32_bf16 a[60:63], v[144:147], a[240:243], a[60:63]
v_exp_f32 v56, v56
v_mfma_f32_16x16x32_bf16 a[92:95], v[160:163], a[240:243], a[92:95]
v_mfma_f32_16x16x32_bf16 a[92:95], v[164:167], a[244:247], a[92:95]
v_exp_f32 v57, v57
v_mfma_f32_16x16x32_bf16 a[92:95], v[168:171], a[248:251], a[92:95]
v_perm_b32 v238, v57, v56, s84
v_mfma_f32_16x16x32_bf16 a[92:95], v[172:175], a[252:255], a[92:95]
v_exp_f32 v58, v58
v_mfma_f32_16x16x32_bf16 a[124:127], v[188:191], a[252:255], a[124:127]
v_mfma_f32_16x16x32_bf16 a[124:127], v[184:187], a[248:251], a[124:127]
v_exp_f32 v59, v59
v_mfma_f32_16x16x32_bf16 a[124:127], v[180:183], a[244:247], a[124:127]
v_perm_b32 v239, v59, v58, s84
v_mfma_f32_16x16x32_bf16 a[124:127], v[176:179], a[240:243], a[124:127]
s_waitcnt lgkmcnt(0)
v_exp_f32 v60, v60
v_smfmac_f32_16x16x64_bf16 v[84:87], v[80:83], v[192:199], v45
s_mov_b32 s36, 0x53800000
ds_read_b64_tr_b16 a[240:241], v33 offset:32
v_exp_f32 v61, v61
v_smfmac_f32_16x16x64_bf16 v[84:87], v[80:83], v[200:207], v45
ds_read_b64_tr_b16 a[242:243], v33 offset:288
v_perm_b32 v254, v61, v60, s84
v_smfmac_f32_16x16x64_bf16 v[88:91], v[80:83], v[208:215], v45
ds_read_b64_tr_b16 a[244:245], v33 offset:544
v_exp_f32 v62, v62
v_smfmac_f32_16x16x64_bf16 v[88:91], v[80:83], v[216:223], v45
ds_read_b64_tr_b16 a[246:247], v33 offset:800
v_exp_f32 v63, v63
v_smfmac_f32_16x16x64_bf16 v[92:95], v[80:83], v[224:231], v45
ds_read_b64_tr_b16 a[248:249], v33 offset:16928
v_perm_b32 v255, v63, v62, s84
v_smfmac_f32_16x16x64_bf16 v[92:95], v[80:83], v[232:239], v45
ds_read_b64_tr_b16 a[250:251], v33 offset:17184
ds_read_b64_tr_b16 a[252:253], v33 offset:17440
v_mfma_f32_16x16x32_bf16 a[0:3], v[192:195], a[224:227], a[0:3]
ds_read_b64_tr_b16 a[254:255], v33 offset:17696
v_add_f32 v84, v84, v85
v_mfma_f32_16x16x32_bf16 a[0:3], v[196:199], a[228:231], a[0:3]
ds_read_b64_tr_b16 a[204:205], v33 offset:17472
v_rcp_f32 v20, v84
v_mfma_f32_16x16x32_bf16 a[0:3], v[200:203], a[232:235], a[0:3]
ds_read_b64_tr_b16 a[206:207], v33 offset:17728
v_add_f32 v88, v88, v89
v_mfma_f32_16x16x32_bf16 a[0:3], v[204:207], a[236:239], a[0:3]
ds_read_b64_tr_b16 a[200:201], v33 offset:16960
v_mov_b32_dpp v20, v20 row_shl:4 row_mask:0x2 bank_mask:0xf
v_rcp_f32 v21, v88
v_smfmac_f32_16x16x64_bf16 v[96:99], v[80:83], v[240:247], v45
ds_read_b64_tr_b16 a[202:203], v33 offset:17216
v_add_f32 v92, v92, v93
v_smfmac_f32_16x16x64_bf16 v[96:99], v[80:83], v[248:255], v45
ds_read_b64_tr_b16 a[196:197], v33 offset:576
v_mov_b32_dpp v20, v20 row_shl:8 row_mask:0x4 bank_mask:0xf
v_mov_b32_dpp v21, v21 row_shl:4 row_mask:0x2 bank_mask:0xf
v_rcp_f32 v22, v92
v_mfma_f32_16x16x32_bf16 a[32:35], v[220:223], a[236:239], a[32:35]
ds_read_b64_tr_b16 a[198:199], v33 offset:832
ds_read_b64_tr_b16 a[192:193], v33 offset:64
v_mfma_f32_16x16x32_bf16 a[32:35], v[216:219], a[232:235], a[32:35]
ds_read_b64_tr_b16 a[194:195], v33 offset:320
v_mov_b32_dpp v20, v20 row_shl:12 row_mask:0x8 bank_mask:0xf
v_mov_b32_dpp v21, v21 row_shl:8 row_mask:0x4 bank_mask:0xf
v_mov_b32_dpp v22, v22 row_shl:4 row_mask:0x2 bank_mask:0xf
v_mfma_f32_16x16x32_bf16 a[32:35], v[212:215], a[228:231], a[32:35]
ds_read_b64_tr_b16 a[208:209], v33 offset:96
ds_read_b64_tr_b16 a[210:211], v33 offset:352
v_mfma_f32_16x16x32_bf16 a[32:35], v[208:211], a[224:227], a[32:35]
ds_read_b64_tr_b16 a[212:213], v33 offset:608
v_mov_b32_dpp v21, v21 row_shl:12 row_mask:0x8 bank_mask:0xf
v_mov_b32_dpp v22, v22 row_shl:8 row_mask:0x4 bank_mask:0xf
v_accvgpr_read_b32 v64, a0
v_mfma_f32_16x16x32_bf16 a[64:67], v[224:227], a[224:227], a[64:67]
ds_read_b64_tr_b16 a[214:215], v33 offset:864
v_add_f32 v96, v96, v97
v_accvgpr_read_b32 v65, a1
v_mfma_f32_16x16x32_bf16 a[64:67], v[228:231], a[228:231], a[64:67]
ds_read_b64_tr_b16 a[216:217], v33 offset:16992
v_mov_b32_dpp v22, v22 row_shl:12 row_mask:0x8 bank_mask:0xf
v_rcp_f32 v23, v96
v_accvgpr_read_b32 v66, a2
v_mfma_f32_16x16x32_bf16 a[64:67], v[232:235], a[232:235], a[64:67]
ds_read_b64_tr_b16 a[218:219], v33 offset:17248
v_accvgpr_read_b32 v67, a3
v_mfma_f32_16x16x32_bf16 a[64:67], v[236:239], a[236:239], a[64:67]
ds_read_b64_tr_b16 a[220:221], v33 offset:17504
v_mov_b32_dpp v23, v23 row_shl:4 row_mask:0x2 bank_mask:0xf
v_mul_f32_dpp v64, v20, v64 row_newbcast:0 row_mask:0xf bank_mask:0xf
v_mfma_f32_16x16x32_bf16 a[96:99], v[252:255], a[236:239], a[96:99]
ds_read_b64_tr_b16 a[222:223], v33 offset:17760
v_add_f32 v25, v84, v88
v_add_f32 v26, v92, v96
v_mul_f32_dpp v65, v20, v65 row_newbcast:1 row_mask:0xf bank_mask:0xf
v_mfma_f32_16x16x32_bf16 a[96:99], v[248:251], a[232:235], a[96:99]
ds_read_b64_tr_b16 v[140:141], v33 offset:17568
v_mov_b32_dpp v23, v23 row_shl:8 row_mask:0x4 bank_mask:0xf
v_add_f32 v25, v25, v26
v_mul_f32_dpp v66, v20, v66 row_newbcast:2 row_mask:0xf bank_mask:0xf
v_mfma_f32_16x16x32_bf16 a[96:99], v[244:247], a[228:231], a[96:99]
ds_read_b64_tr_b16 v[142:143], v33 offset:17824
v_cmp_nge_f32 vcc, s36, v25
v_mul_f32_dpp v67, v20, v67 row_newbcast:3 row_mask:0xf bank_mask:0xf
v_mfma_f32_16x16x32_bf16 a[96:99], v[240:243], a[224:227], a[96:99]
s_waitcnt lgkmcnt(15)
ds_read_b64_tr_b16 v[136:137], v33 offset:17056
v_mov_b32_dpp v23, v23 row_shl:12 row_mask:0x8 bank_mask:0xf
v_mfma_f32_16x16x32_bf16 a[4:7], v[192:195], a[240:243], a[4:7]
ds_read_b64_tr_b16 a[224:225], v33 offset:128
ds_read_b64_tr_b16 a[226:227], v33 offset:384
v_mfma_f32_16x16x32_bf16 a[4:7], v[196:199], a[244:247], a[4:7]
ds_read_b64_tr_b16 a[228:229], v33 offset:640
ds_read_b64_tr_b16 a[230:231], v33 offset:896
v_mfma_f32_16x16x32_bf16 a[4:7], v[200:203], a[248:251], a[4:7]
ds_read_b64_tr_b16 a[232:233], v33 offset:17024
ds_read_b64_tr_b16 a[234:235], v33 offset:17280
v_mfma_f32_16x16x32_bf16 a[4:7], v[204:207], a[252:255], a[4:7]
ds_read_b64_tr_b16 a[236:237], v33 offset:17536
ds_read_b64_tr_b16 a[238:239], v33 offset:17792
v_mfma_f32_16x16x32_bf16 a[8:11], v[204:207], a[204:207], a[8:11]
s_waitcnt lgkmcnt(15)
ds_read_b64_tr_b16 v[138:139], v33 offset:17312
ds_read_b64_tr_b16 v[132:133], v33 offset:672
v_mfma_f32_16x16x32_bf16 a[8:11], v[200:203], a[200:203], a[8:11]
ds_read_b64_tr_b16 v[134:135], v33 offset:928
ds_read_b64_tr_b16 v[128:129], v33 offset:160
v_mfma_f32_16x16x32_bf16 a[8:11], v[196:199], a[196:199], a[8:11]
ds_read_b64_tr_b16 v[130:131], v33 offset:416
v_accvgpr_read_b32 v68, a4
v_accvgpr_read_b32 v69, a5
v_accvgpr_read_b32 v70, a6
v_mfma_f32_16x16x32_bf16 a[8:11], v[192:195], a[192:195], a[8:11]
ds_read_b64_tr_b16 v[144:145], v33 offset:192
v_accvgpr_read_b32 v71, a7
v_mul_f32_dpp v68, v20, v68 row_newbcast:0 row_mask:0xf bank_mask:0xf
v_mul_f32_dpp v69, v20, v69 row_newbcast:1 row_mask:0xf bank_mask:0xf
v_mfma_f32_16x16x32_bf16 a[12:15], v[192:195], a[208:211], a[12:15]
ds_read_b64_tr_b16 v[146:147], v33 offset:448
v_mul_f32_dpp v70, v20, v70 row_newbcast:2 row_mask:0xf bank_mask:0xf
v_mul_f32_dpp v71, v20, v71 row_newbcast:3 row_mask:0xf bank_mask:0xf
v_cvt_pk_bf16_f32 v176, v64, v68
v_mfma_f32_16x16x32_bf16 a[12:15], v[196:199], a[212:215], a[12:15]
s_waitcnt lgkmcnt(15)
ds_read_b64_tr_b16 v[148:149], v33 offset:704
v_cvt_pk_bf16_f32 v178, v65, v69
v_cvt_pk_bf16_f32 v180, v66, v70
v_cvt_pk_bf16_f32 v182, v67, v71
v_mfma_f32_16x16x32_bf16 a[12:15], v[200:203], a[216:219], a[12:15]
ds_read_b64_tr_b16 v[150:151], v33 offset:960
v_accvgpr_read_b32 v72, a8
v_accvgpr_read_b32 v73, a9
v_mfma_f32_16x16x32_bf16 a[12:15], v[204:207], a[220:223], a[12:15]
ds_read_b64_tr_b16 v[152:153], v33 offset:17088
v_accvgpr_read_b32 v74, a10
v_accvgpr_read_b32 v75, a11
v_mfma_f32_16x16x32_bf16 a[36:39], v[220:223], a[252:255], a[36:39]
ds_read_b64_tr_b16 v[154:155], v33 offset:17344
v_mul_f32_dpp v72, v20, v72 row_newbcast:0 row_mask:0xf bank_mask:0xf
v_mul_f32_dpp v73, v20, v73 row_newbcast:1 row_mask:0xf bank_mask:0xf
v_mfma_f32_16x16x32_bf16 a[36:39], v[216:219], a[248:251], a[36:39]
ds_read_b64_tr_b16 v[156:157], v33 offset:17600
v_mul_f32_dpp v74, v20, v74 row_newbcast:2 row_mask:0xf bank_mask:0xf
v_mul_f32_dpp v75, v20, v75 row_newbcast:3 row_mask:0xf bank_mask:0xf
v_mfma_f32_16x16x32_bf16 a[36:39], v[212:215], a[244:247], a[36:39]
ds_read_b64_tr_b16 v[158:159], v33 offset:17856
v_accvgpr_read_b32 v76, a12
v_accvgpr_read_b32 v77, a13
v_accvgpr_read_b32 v78, a14
v_accvgpr_read_b32 v79, a15
v_mfma_f32_16x16x32_bf16 a[36:39], v[208:211], a[240:243], a[36:39]
ds_read_b64_tr_b16 v[172:173], v33 offset:17632
v_mul_f32_dpp v76, v20, v76 row_newbcast:0 row_mask:0xf bank_mask:0xf
v_mul_f32_dpp v77, v20, v77 row_newbcast:1 row_mask:0xf bank_mask:0xf
v_mul_f32_dpp v78, v20, v78 row_newbcast:2 row_mask:0xf bank_mask:0xf
v_mul_f32_dpp v79, v20, v79 row_newbcast:3 row_mask:0xf bank_mask:0xf
v_mfma_f32_16x16x32_bf16 a[40:43], v[208:211], a[192:195], a[40:43]
ds_read_b64_tr_b16 v[174:175], v33 offset:17888
v_cvt_pk_bf16_f32 v177, v72, v76
v_cvt_pk_bf16_f32 v179, v73, v77
v_cvt_pk_bf16_f32 v181, v74, v78
v_cvt_pk_bf16_f32 v183, v75, v79
v_mfma_f32_16x16x32_bf16 a[40:43], v[212:215], a[196:199], a[40:43]
ds_write_b64 v32, v[176:177] offset:33792
v_accvgpr_read_b32 v64, a32
v_accvgpr_read_b32 v65, a33
v_mfma_f32_16x16x32_bf16 a[40:43], v[216:219], a[200:203], a[40:43]
ds_write_b64 v32, v[178:179] offset:33920
v_accvgpr_read_b32 v66, a34
v_accvgpr_read_b32 v67, a35
v_mfma_f32_16x16x32_bf16 a[40:43], v[220:223], a[204:207], a[40:43]
ds_read_b64_tr_b16 a[0:1], v44 offset:33792
ds_read_b64_tr_b16 a[2:3], v37 offset:33792
v_mul_f32_dpp v64, v21, v64 row_newbcast:0 row_mask:0xf bank_mask:0xf
v_mul_f32_dpp v65, v21, v65 row_newbcast:1 row_mask:0xf bank_mask:0xf
v_mul_f32_dpp v66, v21, v66 row_newbcast:2 row_mask:0xf bank_mask:0xf
v_mfma_f32_16x16x32_bf16 a[44:47], v[220:223], a[220:223], a[44:47]
ds_write_b64 v32, v[180:181] offset:34048
v_mul_f32_dpp v67, v21, v67 row_newbcast:3 row_mask:0xf bank_mask:0xf
v_accvgpr_read_b32 v68, a36
v_mfma_f32_16x16x32_bf16 a[44:47], v[216:219], a[216:219], a[44:47]
ds_write_b64 v32, v[182:183] offset:34176
v_accvgpr_read_b32 v69, a37
v_accvgpr_read_b32 v70, a38
v_mfma_f32_16x16x32_bf16 a[44:47], v[212:215], a[212:215], a[44:47]
ds_read_b64_tr_b16 a[4:5], v44 offset:34048
ds_read_b64_tr_b16 a[6:7], v37 offset:34048
v_accvgpr_read_b32 v71, a39
v_mul_f32_dpp v68, v21, v68 row_newbcast:0 row_mask:0xf bank_mask:0xf
v_mul_f32_dpp v69, v21, v69 row_newbcast:1 row_mask:0xf bank_mask:0xf
v_mfma_f32_16x16x32_bf16 a[44:47], v[208:211], a[208:211], a[44:47]
ds_read_b64_tr_b16 v[168:169], v33 offset:17120
v_mul_f32_dpp v70, v21, v70 row_newbcast:2 row_mask:0xf bank_mask:0xf
v_mul_f32_dpp v71, v21, v71 row_newbcast:3 row_mask:0xf bank_mask:0xf
v_cvt_pk_bf16_f32 v184, v64, v68
v_cvt_pk_bf16_f32 v186, v65, v69
v_mfma_f32_16x16x32_bf16 a[68:71], v[224:227], a[240:243], a[68:71]
s_waitcnt lgkmcnt(5)
buffer_store_dwordx4 a[0:3], v9, s[16:19], s80 offen offset:0 sc0 sc1 nt
v_cvt_pk_bf16_f32 v188, v66, v70
v_cvt_pk_bf16_f32 v190, v67, v71
v_accvgpr_read_b32 v72, a40
v_mfma_f32_16x16x32_bf16 a[68:71], v[228:231], a[244:247], a[68:71]
ds_read_b64_tr_b16 v[170:171], v33 offset:17376
v_accvgpr_read_b32 v73, a41
v_accvgpr_read_b32 v74, a42
v_accvgpr_read_b32 v75, a43
v_mul_f32_dpp v72, v21, v72 row_newbcast:0 row_mask:0xf bank_mask:0xf
v_mfma_f32_16x16x32_bf16 a[68:71], v[232:235], a[248:251], a[68:71]
ds_read_b64_tr_b16 v[164:165], v33 offset:736
v_mul_f32_dpp v73, v21, v73 row_newbcast:1 row_mask:0xf bank_mask:0xf
v_mul_f32_dpp v74, v21, v74 row_newbcast:2 row_mask:0xf bank_mask:0xf
v_mul_f32_dpp v75, v21, v75 row_newbcast:3 row_mask:0xf bank_mask:0xf
v_accvgpr_read_b32 v76, a44
v_mfma_f32_16x16x32_bf16 a[68:71], v[236:239], a[252:255], a[68:71]
s_waitcnt lgkmcnt(3)
buffer_store_dwordx4 a[4:7], v9, s[16:19], s80 offen offset:512 sc0 sc1 nt
v_accvgpr_read_b32 v77, a45
v_accvgpr_read_b32 v78, a46
v_accvgpr_read_b32 v79, a47
v_mfma_f32_16x16x32_bf16 a[72:75], v[236:239], a[204:207], a[72:75]
ds_read_b64_tr_b16 v[166:167], v33 offset:992
v_mul_f32_dpp v76, v21, v76 row_newbcast:0 row_mask:0xf bank_mask:0xf
v_mul_f32_dpp v77, v21, v77 row_newbcast:1 row_mask:0xf bank_mask:0xf
v_mul_f32_dpp v78, v21, v78 row_newbcast:2 row_mask:0xf bank_mask:0xf
v_mul_f32_dpp v79, v21, v79 row_newbcast:3 row_mask:0xf bank_mask:0xf
v_mfma_f32_16x16x32_bf16 a[72:75], v[232:235], a[200:203], a[72:75]
ds_read_b64_tr_b16 v[160:161], v33 offset:224
v_cvt_pk_bf16_f32 v185, v72, v76
v_cvt_pk_bf16_f32 v187, v73, v77
v_cvt_pk_bf16_f32 v189, v74, v78
v_cvt_pk_bf16_f32 v191, v75, v79
v_mfma_f32_16x16x32_bf16 a[72:75], v[228:231], a[196:199], a[72:75]
ds_write_b64 v32, v[184:185] offset:35840
v_accvgpr_read_b32 v64, a64
v_accvgpr_read_b32 v65, a65
v_mfma_f32_16x16x32_bf16 a[72:75], v[224:227], a[192:195], a[72:75]
ds_write_b64 v32, v[186:187] offset:35968
v_accvgpr_read_b32 v66, a66
v_accvgpr_read_b32 v67, a67
v_mfma_f32_16x16x32_bf16 a[76:79], v[224:227], a[208:211], a[76:79]
ds_read_b64_tr_b16 a[32:33], v44 offset:35840
ds_read_b64_tr_b16 a[34:35], v37 offset:35840
v_mul_f32_dpp v64, v22, v64 row_newbcast:0 row_mask:0xf bank_mask:0xf
v_mul_f32_dpp v65, v22, v65 row_newbcast:1 row_mask:0xf bank_mask:0xf
v_mul_f32_dpp v66, v22, v66 row_newbcast:2 row_mask:0xf bank_mask:0xf
v_mfma_f32_16x16x32_bf16 a[76:79], v[228:231], a[212:215], a[76:79]
ds_write_b64 v32, v[188:189] offset:36096
v_mul_f32_dpp v67, v22, v67 row_newbcast:3 row_mask:0xf bank_mask:0xf
v_accvgpr_read_b32 v68, a68
v_mfma_f32_16x16x32_bf16 a[76:79], v[232:235], a[216:219], a[76:79]
ds_write_b64 v32, v[190:191] offset:36224
v_accvgpr_read_b32 v69, a69
v_accvgpr_read_b32 v70, a70
v_mfma_f32_16x16x32_bf16 a[76:79], v[236:239], a[220:223], a[76:79]
ds_read_b64_tr_b16 a[36:37], v44 offset:36096
ds_read_b64_tr_b16 a[38:39], v37 offset:36096
v_accvgpr_read_b32 v71, a71
v_mul_f32_dpp v68, v22, v68 row_newbcast:0 row_mask:0xf bank_mask:0xf
v_mul_f32_dpp v69, v22, v69 row_newbcast:1 row_mask:0xf bank_mask:0xf
v_mfma_f32_16x16x32_bf16 a[100:103], v[252:255], a[252:255], a[100:103]
ds_read_b64_tr_b16 v[162:163], v33 offset:480
v_mul_f32_dpp v70, v22, v70 row_newbcast:2 row_mask:0xf bank_mask:0xf
v_mul_f32_dpp v71, v22, v71 row_newbcast:3 row_mask:0xf bank_mask:0xf
v_cvt_pk_bf16_f32 v100, v64, v68
v_cvt_pk_bf16_f32 v102, v65, v69
v_mfma_f32_16x16x32_bf16 a[100:103], v[248:251], a[248:251], a[100:103]
s_waitcnt lgkmcnt(5)
buffer_store_dwordx4 a[32:35], v9, s[16:19], s81 offen offset:0 sc0 sc1 nt
v_cvt_pk_bf16_f32 v104, v66, v70
v_cvt_pk_bf16_f32 v106, v67, v71
v_accvgpr_read_b32 v72, a72
v_mfma_f32_16x16x32_bf16 a[100:103], v[244:247], a[244:247], a[100:103]
v_accvgpr_read_b32 v73, a73
v_accvgpr_read_b32 v74, a74
v_accvgpr_read_b32 v75, a75
v_mul_f32_dpp v72, v22, v72 row_newbcast:0 row_mask:0xf bank_mask:0xf
v_mul_f32_dpp v73, v22, v73 row_newbcast:1 row_mask:0xf bank_mask:0xf
v_mfma_f32_16x16x32_bf16 a[100:103], v[240:243], a[240:243], a[100:103]
v_mul_f32_dpp v74, v22, v74 row_newbcast:2 row_mask:0xf bank_mask:0xf
v_mul_f32_dpp v75, v22, v75 row_newbcast:3 row_mask:0xf bank_mask:0xf
v_accvgpr_read_b32 v76, a76
v_accvgpr_read_b32 v77, a77
v_accvgpr_read_b32 v78, a78
v_mfma_f32_16x16x32_bf16 a[104:107], v[240:243], a[192:195], a[104:107]
s_waitcnt lgkmcnt(1)
buffer_store_dwordx4 a[36:39], v9, s[16:19], s81 offen offset:512 sc0 sc1 nt
v_accvgpr_read_b32 v79, a79
v_mul_f32_dpp v76, v22, v76 row_newbcast:0 row_mask:0xf bank_mask:0xf
v_mul_f32_dpp v77, v22, v77 row_newbcast:1 row_mask:0xf bank_mask:0xf
v_mfma_f32_16x16x32_bf16 a[104:107], v[244:247], a[196:199], a[104:107]
v_mul_f32_dpp v78, v22, v78 row_newbcast:2 row_mask:0xf bank_mask:0xf
v_mul_f32_dpp v79, v22, v79 row_newbcast:3 row_mask:0xf bank_mask:0xf
v_cvt_pk_bf16_f32 v101, v72, v76
v_cvt_pk_bf16_f32 v103, v73, v77
v_cvt_pk_bf16_f32 v105, v74, v78
v_mfma_f32_16x16x32_bf16 a[104:107], v[248:251], a[200:203], a[104:107]
ds_write_b64 v32, v[100:101] offset:50688
v_cvt_pk_bf16_f32 v107, v75, v79
v_accvgpr_read_b32 v64, a96
v_mfma_f32_16x16x32_bf16 a[104:107], v[252:255], a[204:207], a[104:107]
ds_write_b64 v32, v[102:103] offset:50816
v_accvgpr_read_b32 v65, a97
v_accvgpr_read_b32 v66, a98
v_mfma_f32_16x16x32_bf16 a[108:111], v[252:255], a[220:223], a[108:111]
ds_read_b64_tr_b16 a[64:65], v44 offset:50688
ds_read_b64_tr_b16 a[66:67], v37 offset:50688
v_accvgpr_read_b32 v67, a99
v_mul_f32_dpp v64, v23, v64 row_newbcast:0 row_mask:0xf bank_mask:0xf
v_mul_f32_dpp v65, v23, v65 row_newbcast:1 row_mask:0xf bank_mask:0xf
v_mfma_f32_16x16x32_bf16 a[108:111], v[248:251], a[216:219], a[108:111]
ds_write_b64 v32, v[104:105] offset:50944
v_mul_f32_dpp v66, v23, v66 row_newbcast:2 row_mask:0xf bank_mask:0xf
v_mul_f32_dpp v67, v23, v67 row_newbcast:3 row_mask:0xf bank_mask:0xf
v_mfma_f32_16x16x32_bf16 a[108:111], v[244:247], a[212:215], a[108:111]
ds_write_b64 v32, v[106:107] offset:51072
v_accvgpr_read_b32 v68, a100
v_accvgpr_read_b32 v69, a101
v_mfma_f32_16x16x32_bf16 a[108:111], v[240:243], a[208:211], a[108:111]
ds_read_b64_tr_b16 a[68:69], v44 offset:50944
ds_read_b64_tr_b16 a[70:71], v37 offset:50944
v_accvgpr_read_b32 v70, a102
v_accvgpr_read_b32 v71, a103
v_mul_f32_dpp v68, v23, v68 row_newbcast:0 row_mask:0xf bank_mask:0xf
v_mfma_f32_16x16x32_bf16 a[16:19], v[192:195], a[224:227], a[16:19]
v_mul_f32_dpp v69, v23, v69 row_newbcast:1 row_mask:0xf bank_mask:0xf
v_mul_f32_dpp v70, v23, v70 row_newbcast:2 row_mask:0xf bank_mask:0xf
v_mul_f32_dpp v71, v23, v71 row_newbcast:3 row_mask:0xf bank_mask:0xf
v_cvt_pk_bf16_f32 v108, v64, v68
v_cvt_pk_bf16_f32 v110, v65, v69
v_mfma_f32_16x16x32_bf16 a[16:19], v[196:199], a[228:231], a[16:19]
s_waitcnt lgkmcnt(4)
buffer_store_dwordx4 a[64:67], v9, s[16:19], s82 offen offset:0 sc0 sc1 nt
v_cvt_pk_bf16_f32 v112, v66, v70
v_cvt_pk_bf16_f32 v114, v67, v71
v_accvgpr_read_b32 v72, a104
v_mfma_f32_16x16x32_bf16 a[16:19], v[200:203], a[232:235], a[16:19]
v_accvgpr_read_b32 v73, a105
v_accvgpr_read_b32 v74, a106
v_accvgpr_read_b32 v75, a107
v_mul_f32_dpp v72, v23, v72 row_newbcast:0 row_mask:0xf bank_mask:0xf
v_mul_f32_dpp v73, v23, v73 row_newbcast:1 row_mask:0xf bank_mask:0xf
v_mfma_f32_16x16x32_bf16 a[16:19], v[204:207], a[236:239], a[16:19]
v_mul_f32_dpp v74, v23, v74 row_newbcast:2 row_mask:0xf bank_mask:0xf
v_mul_f32_dpp v75, v23, v75 row_newbcast:3 row_mask:0xf bank_mask:0xf
v_accvgpr_read_b32 v76, a108
v_accvgpr_read_b32 v77, a109
v_accvgpr_read_b32 v78, a110
v_mfma_f32_16x16x32_bf16 a[20:23], v[204:207], v[140:143], a[20:23]
s_waitcnt lgkmcnt(0)
buffer_store_dwordx4 a[68:71], v9, s[16:19], s82 offen offset:512 sc0 sc1 nt
v_accvgpr_read_b32 v79, a111
v_mul_f32_dpp v76, v23, v76 row_newbcast:0 row_mask:0xf bank_mask:0xf
v_mul_f32_dpp v77, v23, v77 row_newbcast:1 row_mask:0xf bank_mask:0xf
v_mfma_f32_16x16x32_bf16 a[20:23], v[200:203], v[136:139], a[20:23]
v_mul_f32_dpp v78, v23, v78 row_newbcast:2 row_mask:0xf bank_mask:0xf
v_mul_f32_dpp v79, v23, v79 row_newbcast:3 row_mask:0xf bank_mask:0xf
v_cvt_pk_bf16_f32 v109, v72, v76
v_cvt_pk_bf16_f32 v111, v73, v77
v_cvt_pk_bf16_f32 v113, v74, v78
v_mfma_f32_16x16x32_bf16 a[20:23], v[196:199], v[132:135], a[20:23]
ds_write_b64 v32, v[108:109] offset:52736
v_cvt_pk_bf16_f32 v115, v75, v79
v_accvgpr_read_b32 v64, a16
v_mfma_f32_16x16x32_bf16 a[20:23], v[192:195], v[128:131], a[20:23]
ds_write_b64 v32, v[110:111] offset:52864
v_accvgpr_read_b32 v65, a17
v_accvgpr_read_b32 v66, a18
v_mfma_f32_16x16x32_bf16 a[24:27], v[192:195], v[144:147], a[24:27]
ds_read_b64_tr_b16 a[96:97], v44 offset:52736
ds_read_b64_tr_b16 a[98:99], v37 offset:52736
v_accvgpr_read_b32 v67, a19
v_mul_f32_dpp v64, v20, v64 row_newbcast:0 row_mask:0xf bank_mask:0xf
v_mul_f32_dpp v65, v20, v65 row_newbcast:1 row_mask:0xf bank_mask:0xf
v_mfma_f32_16x16x32_bf16 a[24:27], v[196:199], v[148:151], a[24:27]
ds_write_b64 v32, v[112:113] offset:52992
v_mul_f32_dpp v66, v20, v66 row_newbcast:2 row_mask:0xf bank_mask:0xf
v_mul_f32_dpp v67, v20, v67 row_newbcast:3 row_mask:0xf bank_mask:0xf
v_mfma_f32_16x16x32_bf16 a[24:27], v[200:203], v[152:155], a[24:27]
ds_write_b64 v32, v[114:115] offset:53120
v_accvgpr_read_b32 v68, a20
v_accvgpr_read_b32 v69, a21
v_mfma_f32_16x16x32_bf16 a[24:27], v[204:207], v[156:159], a[24:27]
ds_read_b64_tr_b16 a[100:101], v44 offset:52992
ds_read_b64_tr_b16 a[102:103], v37 offset:52992
v_accvgpr_read_b32 v70, a22
v_accvgpr_read_b32 v71, a23
v_mul_f32_dpp v68, v20, v68 row_newbcast:0 row_mask:0xf bank_mask:0xf
v_mfma_f32_16x16x32_bf16 a[28:31], v[204:207], v[172:175], a[28:31]
v_mul_f32_dpp v69, v20, v69 row_newbcast:1 row_mask:0xf bank_mask:0xf
v_mul_f32_dpp v70, v20, v70 row_newbcast:2 row_mask:0xf bank_mask:0xf
v_mul_f32_dpp v71, v20, v71 row_newbcast:3 row_mask:0xf bank_mask:0xf
v_cvt_pk_bf16_f32 v176, v64, v68
v_mfma_f32_16x16x32_bf16 a[28:31], v[200:203], v[168:171], a[28:31]
s_waitcnt lgkmcnt(4)
buffer_store_dwordx4 a[96:99], v9, s[16:19], s83 offen offset:0 sc0 sc1 nt
v_cvt_pk_bf16_f32 v178, v65, v69
v_cvt_pk_bf16_f32 v180, v66, v70
v_cvt_pk_bf16_f32 v182, v67, v71
v_mfma_f32_16x16x32_bf16 a[28:31], v[196:199], v[164:167], a[28:31]
v_accvgpr_read_b32 v72, a24
v_accvgpr_read_b32 v73, a25
v_mfma_f32_16x16x32_bf16 a[28:31], v[192:195], v[160:163], a[28:31]
v_accvgpr_read_b32 v74, a26
v_accvgpr_read_b32 v75, a27
v_mfma_f32_16x16x32_bf16 a[48:51], v[208:211], a[224:227], a[48:51]
s_waitcnt lgkmcnt(0)
buffer_store_dwordx4 a[100:103], v9, s[16:19], s83 offen offset:512 sc0 sc1 nt
v_mul_f32_dpp v72, v20, v72 row_newbcast:0 row_mask:0xf bank_mask:0xf
v_mul_f32_dpp v73, v20, v73 row_newbcast:1 row_mask:0xf bank_mask:0xf
v_mfma_f32_16x16x32_bf16 a[48:51], v[212:215], a[228:231], a[48:51]
v_mul_f32_dpp v74, v20, v74 row_newbcast:2 row_mask:0xf bank_mask:0xf
v_mul_f32_dpp v75, v20, v75 row_newbcast:3 row_mask:0xf bank_mask:0xf
v_mfma_f32_16x16x32_bf16 a[48:51], v[216:219], a[232:235], a[48:51]
v_accvgpr_read_b32 v76, a28
v_accvgpr_read_b32 v77, a29
v_accvgpr_read_b32 v78, a30
v_mfma_f32_16x16x32_bf16 a[48:51], v[220:223], a[236:239], a[48:51]
v_accvgpr_read_b32 v79, a31
v_mul_f32_dpp v76, v20, v76 row_newbcast:0 row_mask:0xf bank_mask:0xf
v_mul_f32_dpp v77, v20, v77 row_newbcast:1 row_mask:0xf bank_mask:0xf
v_mfma_f32_16x16x32_bf16 a[52:55], v[220:223], v[140:143], a[52:55]
v_mul_f32_dpp v78, v20, v78 row_newbcast:2 row_mask:0xf bank_mask:0xf
v_mul_f32_dpp v79, v20, v79 row_newbcast:3 row_mask:0xf bank_mask:0xf
v_cvt_pk_bf16_f32 v177, v72, v76
v_mfma_f32_16x16x32_bf16 a[52:55], v[216:219], v[136:139], a[52:55]
ds_write_b64 v32, v[176:177] offset:33792
v_cvt_pk_bf16_f32 v179, v73, v77
v_cvt_pk_bf16_f32 v181, v74, v78
v_mfma_f32_16x16x32_bf16 a[52:55], v[212:215], v[132:135], a[52:55]
ds_write_b64 v32, v[178:179] offset:33920
v_cvt_pk_bf16_f32 v183, v75, v79
v_accvgpr_read_b32 v64, a48
v_mfma_f32_16x16x32_bf16 a[52:55], v[208:211], v[128:131], a[52:55]
ds_read_b64_tr_b16 a[16:17], v44 offset:33792
ds_read_b64_tr_b16 a[18:19], v37 offset:33792
v_accvgpr_read_b32 v65, a49
v_accvgpr_read_b32 v66, a50
v_accvgpr_read_b32 v67, a51
v_mfma_f32_16x16x32_bf16 a[56:59], v[208:211], v[144:147], a[56:59]
ds_write_b64 v32, v[180:181] offset:34048
v_mul_f32_dpp v64, v21, v64 row_newbcast:0 row_mask:0xf bank_mask:0xf
v_mul_f32_dpp v65, v21, v65 row_newbcast:1 row_mask:0xf bank_mask:0xf
v_mfma_f32_16x16x32_bf16 a[56:59], v[212:215], v[148:151], a[56:59]
ds_write_b64 v32, v[182:183] offset:34176
v_mul_f32_dpp v66, v21, v66 row_newbcast:2 row_mask:0xf bank_mask:0xf
v_mul_f32_dpp v67, v21, v67 row_newbcast:3 row_mask:0xf bank_mask:0xf
v_mfma_f32_16x16x32_bf16 a[56:59], v[216:219], v[152:155], a[56:59]
ds_read_b64_tr_b16 a[20:21], v44 offset:34048
ds_read_b64_tr_b16 a[22:23], v37 offset:34048
v_accvgpr_read_b32 v68, a52
v_accvgpr_read_b32 v69, a53
v_accvgpr_read_b32 v70, a54
v_mfma_f32_16x16x32_bf16 a[56:59], v[220:223], v[156:159], a[56:59]
v_accvgpr_read_b32 v71, a55
v_mul_f32_dpp v68, v21, v68 row_newbcast:0 row_mask:0xf bank_mask:0xf
v_mul_f32_dpp v69, v21, v69 row_newbcast:1 row_mask:0xf bank_mask:0xf
v_mfma_f32_16x16x32_bf16 a[60:63], v[220:223], v[172:175], a[60:63]
s_waitcnt lgkmcnt(4)
buffer_store_dwordx4 a[16:19], v9, s[16:19], s80 offen offset:128 sc0 sc1 nt
v_mul_f32_dpp v70, v21, v70 row_newbcast:2 row_mask:0xf bank_mask:0xf
v_mul_f32_dpp v71, v21, v71 row_newbcast:3 row_mask:0xf bank_mask:0xf
v_cvt_pk_bf16_f32 v184, v64, v68
v_mfma_f32_16x16x32_bf16 a[60:63], v[216:219], v[168:171], a[60:63]
v_cvt_pk_bf16_f32 v186, v65, v69
v_cvt_pk_bf16_f32 v188, v66, v70
v_cvt_pk_bf16_f32 v190, v67, v71
v_mfma_f32_16x16x32_bf16 a[60:63], v[212:215], v[164:167], a[60:63]
v_accvgpr_read_b32 v72, a56
v_accvgpr_read_b32 v73, a57
v_mfma_f32_16x16x32_bf16 a[60:63], v[208:211], v[160:163], a[60:63]
s_waitcnt lgkmcnt(0)
buffer_store_dwordx4 a[20:23], v9, s[16:19], s80 offen offset:640 sc0 sc1 nt
v_accvgpr_read_b32 v74, a58
v_accvgpr_read_b32 v75, a59
v_mfma_f32_16x16x32_bf16 a[80:83], v[224:227], a[224:227], a[80:83]
v_mul_f32_dpp v72, v21, v72 row_newbcast:0 row_mask:0xf bank_mask:0xf
v_mul_f32_dpp v73, v21, v73 row_newbcast:1 row_mask:0xf bank_mask:0xf
v_mfma_f32_16x16x32_bf16 a[80:83], v[228:231], a[228:231], a[80:83]
v_mul_f32_dpp v74, v21, v74 row_newbcast:2 row_mask:0xf bank_mask:0xf
v_mul_f32_dpp v75, v21, v75 row_newbcast:3 row_mask:0xf bank_mask:0xf
v_mfma_f32_16x16x32_bf16 a[80:83], v[232:235], a[232:235], a[80:83]
v_accvgpr_read_b32 v76, a60
v_accvgpr_read_b32 v77, a61
v_accvgpr_read_b32 v78, a62
v_mfma_f32_16x16x32_bf16 a[80:83], v[236:239], a[236:239], a[80:83]
v_accvgpr_read_b32 v79, a63
v_mul_f32_dpp v76, v21, v76 row_newbcast:0 row_mask:0xf bank_mask:0xf
v_mul_f32_dpp v77, v21, v77 row_newbcast:1 row_mask:0xf bank_mask:0xf
v_mfma_f32_16x16x32_bf16 a[84:87], v[236:239], v[140:143], a[84:87]
v_mul_f32_dpp v78, v21, v78 row_newbcast:2 row_mask:0xf bank_mask:0xf
v_mul_f32_dpp v79, v21, v79 row_newbcast:3 row_mask:0xf bank_mask:0xf
v_cvt_pk_bf16_f32 v185, v72, v76
v_mfma_f32_16x16x32_bf16 a[84:87], v[232:235], v[136:139], a[84:87]
ds_write_b64 v32, v[184:185] offset:35840
v_cvt_pk_bf16_f32 v187, v73, v77
v_cvt_pk_bf16_f32 v189, v74, v78
v_mfma_f32_16x16x32_bf16 a[84:87], v[228:231], v[132:135], a[84:87]
ds_write_b64 v32, v[186:187] offset:35968
v_cvt_pk_bf16_f32 v191, v75, v79
v_accvgpr_read_b32 v64, a80
v_mfma_f32_16x16x32_bf16 a[84:87], v[224:227], v[128:131], a[84:87]
ds_read_b64_tr_b16 a[48:49], v44 offset:35840
ds_read_b64_tr_b16 a[50:51], v37 offset:35840
v_accvgpr_read_b32 v65, a81
v_accvgpr_read_b32 v66, a82
v_accvgpr_read_b32 v67, a83
v_mfma_f32_16x16x32_bf16 a[88:91], v[224:227], v[144:147], a[88:91]
ds_write_b64 v32, v[188:189] offset:36096
v_mul_f32_dpp v64, v22, v64 row_newbcast:0 row_mask:0xf bank_mask:0xf
v_mul_f32_dpp v65, v22, v65 row_newbcast:1 row_mask:0xf bank_mask:0xf
v_mfma_f32_16x16x32_bf16 a[88:91], v[228:231], v[148:151], a[88:91]
ds_write_b64 v32, v[190:191] offset:36224
v_mul_f32_dpp v66, v22, v66 row_newbcast:2 row_mask:0xf bank_mask:0xf
v_mul_f32_dpp v67, v22, v67 row_newbcast:3 row_mask:0xf bank_mask:0xf
v_mfma_f32_16x16x32_bf16 a[88:91], v[232:235], v[152:155], a[88:91]
ds_read_b64_tr_b16 a[52:53], v44 offset:36096
ds_read_b64_tr_b16 a[54:55], v37 offset:36096
v_accvgpr_read_b32 v68, a84
v_accvgpr_read_b32 v69, a85
v_accvgpr_read_b32 v70, a86
v_mfma_f32_16x16x32_bf16 a[88:91], v[236:239], v[156:159], a[88:91]
v_accvgpr_read_b32 v71, a87
v_mul_f32_dpp v68, v22, v68 row_newbcast:0 row_mask:0xf bank_mask:0xf
v_mul_f32_dpp v69, v22, v69 row_newbcast:1 row_mask:0xf bank_mask:0xf
v_mfma_f32_16x16x32_bf16 a[92:95], v[236:239], v[172:175], a[92:95]
s_waitcnt lgkmcnt(4)
buffer_store_dwordx4 a[48:51], v9, s[16:19], s81 offen offset:128 sc0 sc1 nt
v_mul_f32_dpp v70, v22, v70 row_newbcast:2 row_mask:0xf bank_mask:0xf
v_mul_f32_dpp v71, v22, v71 row_newbcast:3 row_mask:0xf bank_mask:0xf
v_cvt_pk_bf16_f32 v100, v64, v68
v_mfma_f32_16x16x32_bf16 a[92:95], v[232:235], v[168:171], a[92:95]
v_cvt_pk_bf16_f32 v102, v65, v69
v_cvt_pk_bf16_f32 v104, v66, v70
v_cvt_pk_bf16_f32 v106, v67, v71
v_mfma_f32_16x16x32_bf16 a[92:95], v[228:231], v[164:167], a[92:95]
v_accvgpr_read_b32 v72, a88
v_accvgpr_read_b32 v73, a89
v_mfma_f32_16x16x32_bf16 a[92:95], v[224:227], v[160:163], a[92:95]
s_waitcnt lgkmcnt(0)
buffer_store_dwordx4 a[52:55], v9, s[16:19], s81 offen offset:640 sc0 sc1 nt
v_accvgpr_read_b32 v74, a90
v_accvgpr_read_b32 v75, a91
v_mfma_f32_16x16x32_bf16 a[112:115], v[240:243], a[224:227], a[112:115]
v_mul_f32_dpp v72, v22, v72 row_newbcast:0 row_mask:0xf bank_mask:0xf
v_mul_f32_dpp v73, v22, v73 row_newbcast:1 row_mask:0xf bank_mask:0xf
v_mfma_f32_16x16x32_bf16 a[112:115], v[244:247], a[228:231], a[112:115]
v_mul_f32_dpp v74, v22, v74 row_newbcast:2 row_mask:0xf bank_mask:0xf
v_mul_f32_dpp v75, v22, v75 row_newbcast:3 row_mask:0xf bank_mask:0xf
v_mfma_f32_16x16x32_bf16 a[112:115], v[248:251], a[232:235], a[112:115]
v_accvgpr_read_b32 v76, a92
v_accvgpr_read_b32 v77, a93
v_accvgpr_read_b32 v78, a94
v_mfma_f32_16x16x32_bf16 a[112:115], v[252:255], a[236:239], a[112:115]
v_accvgpr_read_b32 v79, a95
v_mul_f32_dpp v76, v22, v76 row_newbcast:0 row_mask:0xf bank_mask:0xf
v_mul_f32_dpp v77, v22, v77 row_newbcast:1 row_mask:0xf bank_mask:0xf
v_mfma_f32_16x16x32_bf16 a[116:119], v[252:255], v[140:143], a[116:119]
v_mul_f32_dpp v78, v22, v78 row_newbcast:2 row_mask:0xf bank_mask:0xf
v_mul_f32_dpp v79, v22, v79 row_newbcast:3 row_mask:0xf bank_mask:0xf
v_cvt_pk_bf16_f32 v101, v72, v76
v_mfma_f32_16x16x32_bf16 a[116:119], v[248:251], v[136:139], a[116:119]
ds_write_b64 v32, v[100:101] offset:50688
v_cvt_pk_bf16_f32 v103, v73, v77
v_cvt_pk_bf16_f32 v105, v74, v78
v_mfma_f32_16x16x32_bf16 a[116:119], v[244:247], v[132:135], a[116:119]
ds_write_b64 v32, v[102:103] offset:50816
v_cvt_pk_bf16_f32 v107, v75, v79
v_accvgpr_read_b32 v64, a112
v_mfma_f32_16x16x32_bf16 a[116:119], v[240:243], v[128:131], a[116:119]
ds_read_b64_tr_b16 a[80:81], v44 offset:50688
ds_read_b64_tr_b16 a[82:83], v37 offset:50688
v_accvgpr_read_b32 v65, a113
v_accvgpr_read_b32 v66, a114
v_accvgpr_read_b32 v67, a115
v_mfma_f32_16x16x32_bf16 a[120:123], v[240:243], v[144:147], a[120:123]
ds_write_b64 v32, v[104:105] offset:50944
v_mul_f32_dpp v64, v23, v64 row_newbcast:0 row_mask:0xf bank_mask:0xf
v_mul_f32_dpp v65, v23, v65 row_newbcast:1 row_mask:0xf bank_mask:0xf
v_mfma_f32_16x16x32_bf16 a[120:123], v[244:247], v[148:151], a[120:123]
ds_write_b64 v32, v[106:107] offset:51072
v_mul_f32_dpp v66, v23, v66 row_newbcast:2 row_mask:0xf bank_mask:0xf
v_mul_f32_dpp v67, v23, v67 row_newbcast:3 row_mask:0xf bank_mask:0xf
v_mfma_f32_16x16x32_bf16 a[120:123], v[248:251], v[152:155], a[120:123]
ds_read_b64_tr_b16 a[84:85], v44 offset:50944
ds_read_b64_tr_b16 a[86:87], v37 offset:50944
v_accvgpr_read_b32 v68, a116
v_accvgpr_read_b32 v69, a117
v_accvgpr_read_b32 v70, a118
v_mfma_f32_16x16x32_bf16 a[120:123], v[252:255], v[156:159], a[120:123]
v_accvgpr_read_b32 v71, a119
v_mul_f32_dpp v68, v23, v68 row_newbcast:0 row_mask:0xf bank_mask:0xf
v_mul_f32_dpp v69, v23, v69 row_newbcast:1 row_mask:0xf bank_mask:0xf
v_mfma_f32_16x16x32_bf16 a[124:127], v[252:255], v[172:175], a[124:127]
s_waitcnt lgkmcnt(4)
buffer_store_dwordx4 a[80:83], v9, s[16:19], s82 offen offset:128 sc0 sc1 nt
v_mul_f32_dpp v70, v23, v70 row_newbcast:2 row_mask:0xf bank_mask:0xf
v_mul_f32_dpp v71, v23, v71 row_newbcast:3 row_mask:0xf bank_mask:0xf
v_cvt_pk_bf16_f32 v108, v64, v68
v_mfma_f32_16x16x32_bf16 a[124:127], v[248:251], v[168:171], a[124:127]
v_cvt_pk_bf16_f32 v110, v65, v69
v_cvt_pk_bf16_f32 v112, v66, v70
v_cvt_pk_bf16_f32 v114, v67, v71
v_mfma_f32_16x16x32_bf16 a[124:127], v[244:247], v[164:167], a[124:127]
v_accvgpr_read_b32 v72, a120
v_accvgpr_read_b32 v73, a121
v_accvgpr_read_b32 v74, a122
v_accvgpr_read_b32 v75, a123
v_mfma_f32_16x16x32_bf16 a[124:127], v[240:243], v[160:163], a[124:127]
s_waitcnt lgkmcnt(0)
buffer_store_dwordx4 a[84:87], v9, s[16:19], s82 offen offset:640 sc0 sc1 nt
v_mul_f32_dpp v72, v23, v72 row_newbcast:0 row_mask:0xf bank_mask:0xf
v_mul_f32_dpp v73, v23, v73 row_newbcast:1 row_mask:0xf bank_mask:0xf
v_mul_f32_dpp v74, v23, v74 row_newbcast:2 row_mask:0xf bank_mask:0xf
v_mul_f32_dpp v75, v23, v75 row_newbcast:3 row_mask:0xf bank_mask:0xf
s_nop 1
v_accvgpr_read_b32 v76, a124
v_accvgpr_read_b32 v77, a125
v_accvgpr_read_b32 v78, a126
v_accvgpr_read_b32 v79, a127
v_mul_f32_dpp v76, v23, v76 row_newbcast:0 row_mask:0xf bank_mask:0xf
v_mul_f32_dpp v77, v23, v77 row_newbcast:1 row_mask:0xf bank_mask:0xf
v_mul_f32_dpp v78, v23, v78 row_newbcast:2 row_mask:0xf bank_mask:0xf
v_mul_f32_dpp v79, v23, v79 row_newbcast:3 row_mask:0xf bank_mask:0xf
v_cvt_pk_bf16_f32 v109, v72, v76
v_cvt_pk_bf16_f32 v111, v73, v77
v_cvt_pk_bf16_f32 v113, v74, v78
v_cvt_pk_bf16_f32 v115, v75, v79
ds_write_b64 v32, v[108:109] offset:52736
ds_write_b64 v32, v[110:111] offset:52864
ds_write_b64 v32, v[112:113] offset:52992
ds_write_b64 v32, v[114:115] offset:53120
ds_read_b64_tr_b16 a[112:113], v44 offset:52736
ds_read_b64_tr_b16 a[114:115], v37 offset:52736
ds_read_b64_tr_b16 a[116:117], v44 offset:52992
ds_read_b64_tr_b16 a[118:119], v37 offset:52992
s_waitcnt lgkmcnt(2)
buffer_store_dwordx4 a[112:115], v9, s[16:19], s83 offen offset:128 sc0 sc1 nt
s_waitcnt lgkmcnt(0)
buffer_store_dwordx4 a[116:119], v9, s[16:19], s83 offen offset:640 sc0 sc1 nt
s_cmp_lg_u32 s32, 0
s_cbranch_scc1 L_fin
s_cmp_lg_u64 vcc, 0
s_cselect_b32 s36, 1, 0
s_lshl_b32 s37, s3, 2
s_add_u32 s37, s37, 135168
v_mov_b32 v20, s36
v_mov_b32 v21, s37
v_mov_b32 v22, 135168
ds_write_b32 v21, v20
s_waitcnt lgkmcnt(0)
s_barrier
ds_read_b128 v[28:31], v22
s_waitcnt lgkmcnt(0)
v_or3_b32 v20, v28, v29, v30
v_or_b32 v20, v20, v31
s_nop 1
v_readfirstlane_b32 s36, v20
s_nop 3
s_cmp_eq_u32 s36, 0
s_cbranch_scc0 L_redo
L_fin:
L_end:
s_endpgm
L_redo:
s_mov_b32 s32, 1
s_mov_b32 s20, 0
s_waitcnt vmcnt(0)
L_maxpass:
s_barrier
s_add_u32 m0, s22, 0
s_nop 0
buffer_load_dwordx4 v2, s[8:11], s20 offen offset:0 nt lds
buffer_load_dwordx4 v3, s[8:11], s20 offen offset:1056 nt lds
buffer_load_dwordx4 v4, s[8:11], s20 offen offset:2112 nt lds
buffer_load_dwordx4 v5, s[8:11], s20 offen offset:3168 nt lds
s_sub_u32 s20, s20, s92
s_and_b32 s20, s20, s92
s_waitcnt vmcnt(0)
s_barrier
ds_read_b128 a[192:195], v6 offset:0
ds_read_b128 a[196:199], v6 offset:64
ds_read_b128 a[200:203], v6 offset:128
ds_read_b128 a[204:207], v6 offset:192
s_waitcnt lgkmcnt(0)
v_mfma_f32_16x16x32_bf16 v[48:51], a[192:195], a[128:131], 0
v_mfma_f32_16x16x32_bf16 v[48:51], a[196:199], a[132:135], v[48:51]
v_mfma_f32_16x16x32_bf16 v[48:51], a[200:203], a[136:139], v[48:51]
v_mfma_f32_16x16x32_bf16 v[48:51], a[204:207], a[140:143], v[48:51]
v_mfma_f32_16x16x32_bf16 v[52:55], a[192:195], a[144:147], 0
v_mfma_f32_16x16x32_bf16 v[52:55], a[196:199], a[148:151], v[52:55]
v_mfma_f32_16x16x32_bf16 v[52:55], a[200:203], a[152:155], v[52:55]
v_mfma_f32_16x16x32_bf16 v[52:55], a[204:207], a[156:159], v[52:55]
v_mfma_f32_16x16x32_bf16 v[56:59], a[192:195], a[160:163], 0
v_mfma_f32_16x16x32_bf16 v[56:59], a[196:199], a[164:167], v[56:59]
v_mfma_f32_16x16x32_bf16 v[56:59], a[200:203], a[168:171], v[56:59]
v_mfma_f32_16x16x32_bf16 v[56:59], a[204:207], a[172:175], v[56:59]
v_mfma_f32_16x16x32_bf16 v[60:63], a[192:195], a[176:179], 0
v_mfma_f32_16x16x32_bf16 v[60:63], a[196:199], a[180:183], v[60:63]
v_mfma_f32_16x16x32_bf16 v[60:63], a[200:203], a[184:187], v[60:63]
v_mfma_f32_16x16x32_bf16 v[60:63], a[204:207], a[188:191], v[60:63]
s_nop 7
v_max3_f32 v16, v16, v48, v49
v_max3_f32 v16, v16, v50, v51
v_max3_f32 v17, v17, v52, v53
v_max3_f32 v17, v17, v54, v55
v_max3_f32 v18, v18, v56, v57
v_max3_f32 v18, v18, v58, v59
v_max3_f32 v19, v19, v60, v61
v_max3_f32 v19, v19, v62, v63
ds_read_b128 a[192:195], v6 offset:256
ds_read_b128 a[196:199], v6 offset:320
ds_read_b128 a[200:203], v6 offset:384
ds_read_b128 a[204:207], v6 offset:448
s_waitcnt lgkmcnt(0)
v_mfma_f32_16x16x32_bf16 v[48:51], a[192:195], a[128:131], 0
v_mfma_f32_16x16x32_bf16 v[48:51], a[196:199], a[132:135], v[48:51]
v_mfma_f32_16x16x32_bf16 v[48:51], a[200:203], a[136:139], v[48:51]
v_mfma_f32_16x16x32_bf16 v[48:51], a[204:207], a[140:143], v[48:51]
v_mfma_f32_16x16x32_bf16 v[52:55], a[192:195], a[144:147], 0
v_mfma_f32_16x16x32_bf16 v[52:55], a[196:199], a[148:151], v[52:55]
v_mfma_f32_16x16x32_bf16 v[52:55], a[200:203], a[152:155], v[52:55]
v_mfma_f32_16x16x32_bf16 v[52:55], a[204:207], a[156:159], v[52:55]
v_mfma_f32_16x16x32_bf16 v[56:59], a[192:195], a[160:163], 0
v_mfma_f32_16x16x32_bf16 v[56:59], a[196:199], a[164:167], v[56:59]
v_mfma_f32_16x16x32_bf16 v[56:59], a[200:203], a[168:171], v[56:59]
v_mfma_f32_16x16x32_bf16 v[56:59], a[204:207], a[172:175], v[56:59]
v_mfma_f32_16x16x32_bf16 v[60:63], a[192:195], a[176:179], 0
v_mfma_f32_16x16x32_bf16 v[60:63], a[196:199], a[180:183], v[60:63]
v_mfma_f32_16x16x32_bf16 v[60:63], a[200:203], a[184:187], v[60:63]
v_mfma_f32_16x16x32_bf16 v[60:63], a[204:207], a[188:191], v[60:63]
s_nop 7
v_max3_f32 v16, v16, v48, v49
v_max3_f32 v16, v16, v50, v51
v_max3_f32 v17, v17, v52, v53
v_max3_f32 v17, v17, v54, v55
v_max3_f32 v18, v18, v56, v57
v_max3_f32 v18, v18, v58, v59
v_max3_f32 v19, v19, v60, v61
v_max3_f32 v19, v19, v62, v63
ds_read_b128 a[192:195], v6 offset:512
ds_read_b128 a[196:199], v6 offset:576
ds_read_b128 a[200:203], v6 offset:640
ds_read_b128 a[204:207], v6 offset:704
s_waitcnt lgkmcnt(0)
v_mfma_f32_16x16x32_bf16 v[48:51], a[192:195], a[128:131], 0
v_mfma_f32_16x16x32_bf16 v[48:51], a[196:199], a[132:135], v[48:51]
v_mfma_f32_16x16x32_bf16 v[48:51], a[200:203], a[136:139], v[48:51]
v_mfma_f32_16x16x32_bf16 v[48:51], a[204:207], a[140:143], v[48:51]
v_mfma_f32_16x16x32_bf16 v[52:55], a[192:195], a[144:147], 0
v_mfma_f32_16x16x32_bf16 v[52:55], a[196:199], a[148:151], v[52:55]
v_mfma_f32_16x16x32_bf16 v[52:55], a[200:203], a[152:155], v[52:55]
v_mfma_f32_16x16x32_bf16 v[52:55], a[204:207], a[156:159], v[52:55]
v_mfma_f32_16x16x32_bf16 v[56:59], a[192:195], a[160:163], 0
v_mfma_f32_16x16x32_bf16 v[56:59], a[196:199], a[164:167], v[56:59]
v_mfma_f32_16x16x32_bf16 v[56:59], a[200:203], a[168:171], v[56:59]
v_mfma_f32_16x16x32_bf16 v[56:59], a[204:207], a[172:175], v[56:59]
v_mfma_f32_16x16x32_bf16 v[60:63], a[192:195], a[176:179], 0
v_mfma_f32_16x16x32_bf16 v[60:63], a[196:199], a[180:183], v[60:63]
v_mfma_f32_16x16x32_bf16 v[60:63], a[200:203], a[184:187], v[60:63]
v_mfma_f32_16x16x32_bf16 v[60:63], a[204:207], a[188:191], v[60:63]
s_nop 7
v_max3_f32 v16, v16, v48, v49
v_max3_f32 v16, v16, v50, v51
v_max3_f32 v17, v17, v52, v53
v_max3_f32 v17, v17, v54, v55
v_max3_f32 v18, v18, v56, v57
v_max3_f32 v18, v18, v58, v59
v_max3_f32 v19, v19, v60, v61
v_max3_f32 v19, v19, v62, v63
ds_read_b128 a[192:195], v6 offset:768
ds_read_b128 a[196:199], v6 offset:832
ds_read_b128 a[200:203], v6 offset:896
ds_read_b128 a[204:207], v6 offset:960
s_waitcnt lgkmcnt(0)
v_mfma_f32_16x16x32_bf16 v[48:51], a[192:195], a[128:131], 0
v_mfma_f32_16x16x32_bf16 v[48:51], a[196:199], a[132:135], v[48:51]
v_mfma_f32_16x16x32_bf16 v[48:51], a[200:203], a[136:139], v[48:51]
v_mfma_f32_16x16x32_bf16 v[48:51], a[204:207], a[140:143], v[48:51]
v_mfma_f32_16x16x32_bf16 v[52:55], a[192:195], a[144:147], 0
v_mfma_f32_16x16x32_bf16 v[52:55], a[196:199], a[148:151], v[52:55]
v_mfma_f32_16x16x32_bf16 v[52:55], a[200:203], a[152:155], v[52:55]
v_mfma_f32_16x16x32_bf16 v[52:55], a[204:207], a[156:159], v[52:55]
v_mfma_f32_16x16x32_bf16 v[56:59], a[192:195], a[160:163], 0
v_mfma_f32_16x16x32_bf16 v[56:59], a[196:199], a[164:167], v[56:59]
v_mfma_f32_16x16x32_bf16 v[56:59], a[200:203], a[168:171], v[56:59]
v_mfma_f32_16x16x32_bf16 v[56:59], a[204:207], a[172:175], v[56:59]
v_mfma_f32_16x16x32_bf16 v[60:63], a[192:195], a[176:179], 0
v_mfma_f32_16x16x32_bf16 v[60:63], a[196:199], a[180:183], v[60:63]
v_mfma_f32_16x16x32_bf16 v[60:63], a[200:203], a[184:187], v[60:63]
v_mfma_f32_16x16x32_bf16 v[60:63], a[204:207], a[188:191], v[60:63]
s_nop 7
v_max3_f32 v16, v16, v48, v49
v_max3_f32 v16, v16, v50, v51
v_max3_f32 v17, v17, v52, v53
v_max3_f32 v17, v17, v54, v55
v_max3_f32 v18, v18, v56, v57
v_max3_f32 v18, v18, v58, v59
v_max3_f32 v19, v19, v60, v61
v_max3_f32 v19, v19, v62, v63
s_cmp_lg_u32 s20, 0
s_cbranch_scc1 L_maxpass
s_barrier
s_branch L_start
L_last:
.section .rodata,"a"
.p2align 6
.amdhsa_kernel standalone__mha_softmax__near_ridge_kernel
  .amdhsa_next_free_vgpr 512
  .amdhsa_next_free_sgpr 102
  .amdhsa_accum_offset 256
  .amdhsa_group_segment_fixed_size 0
  .amdhsa_kernarg_size 48
  .amdhsa_user_sgpr_count 2
  .amdhsa_user_sgpr_kernarg_segment_ptr 1
  .amdhsa_system_sgpr_workgroup_id_x 1
  .amdhsa_float_denorm_mode_32 3
.end_amdhsa_kernel
```
